```python
import torch

def _softmax(x, axis=-1):
    return torch.softmax(x, dim=axis)
def _gelu(x):
    return torch.nn.functional.gelu(x, approximate="tanh")
def _silu(x):
    return torch.nn.functional.silu(x)
def _sigmoid(x):
    return torch.sigmoid(x)
def _layernorm(x, axis=-1, eps=1e-5):
    m = x.mean(dim=axis, keepdim=True)
    v = x.var(dim=axis, keepdim=True, unbiased=False)
    return (x - m) / torch.sqrt(v + eps)
def _scatter_add(tgt, idx, src, axis=0):
    return tgt.clone().index_add_(axis, idx, src)
def _segment_sum(src, seg, n):
    out = torch.zeros((n,) + src.shape[1:], dtype=src.dtype)
    return out.index_add_(0, seg, src)
def _pad(x, pw):
    flat = tuple(v for pair in reversed(pw) for v in pair)
    return torch.nn.functional.pad(x, flat)

kernel_name = 'concat_heads__sliding_local_dilated__mha_block__prompt'

def setup_inputs():

    _w = (lambda a: (lambda t: t.to(torch.bfloat16) if t.is_floating_point() else t)(torch.as_tensor(a)))
    def _A_setup():
        B, S, D = 1, 2048, 448
        return {
            "x": _w((lambda *s: torch.randn(*s, dtype=torch.bfloat16) * 0.4)(B, S, D)),
            "wqkv": _w((lambda *s: torch.randn(*s, dtype=torch.bfloat16) * 0.8)(D, 3 * D)),
            "wo": _w((lambda *s: torch.randn(*s, dtype=torch.bfloat16) * 0.1)(D, D)),
        }
    _A_in = _A_setup()

    def _B_setup():
        B, S, D, H = 1, 2048, 448, 16
        return {
            "x": _w((lambda *s: torch.randn(*s, dtype=torch.bfloat16) * 0.2)(B, S, D)),
            "wqkv": _w((lambda *s: torch.randn(*s, dtype=torch.bfloat16) * 0.8)(D, 3 * D)),
            "wo": _w((lambda *s: torch.randn(*s, dtype=torch.bfloat16) * 0.2)(D, D)),
        }
    _B_in = _B_setup()

    return {
        "A_x": _A_in["x"],
        "A_wqkv": _A_in["wqkv"],
        "A_wo": _A_in["wo"],
        "B_x": _B_in["x"],
        "B_wqkv": _B_in["wqkv"],
        "B_wo": _B_in["wo"],
    }

def reference(A_x, A_wqkv, A_wo, B_x, B_wqkv, B_wo):
    def _A_ref(x, wqkv, wo):
        B, S, D = x.shape
        H = 16; Dh = D // H
        W, dil = 8, 2
        qkv = (lambda x, *d: x.permute(*d))((x @ wqkv).reshape(B, S, 3, H, Dh), 2, 0, 3, 1, 4)
        q, k, v = qkv[0], qkv[1], qkv[2]
        scale = Dh ** -0.5
        pos = torch.arange(S)
        off = torch.arange(W) * dil
        idx = pos[:, None] - off[None, :]
        mask = idx >= 0
        idx_c = torch.where(mask, idx, 0).reshape(-1)
        kg = k[:, :, idx_c, :].reshape(B, H, S, W, Dh)
        vg = v[:, :, idx_c, :].reshape(B, H, S, W, Dh)
        logits = torch.einsum("bhsd,bhswd->bhsw", q, kg) * scale
        logits = torch.where(mask[None, None, :, :], logits, -1e9)
        attn = _softmax(logits, axis=-1)
        o = torch.einsum("bhsw,bhswd->bhsd", attn, vg)
        return (lambda x, *d: x.permute(*d))(o, 0, 2, 1, 3).reshape(B, S, D) @ wo

    def _B_ref(x, wqkv, wo):
        B, S, D = x.shape
        H = 16
        Dh = D // H
        qkv = (lambda x, *d: x.permute(*d))((x @ wqkv).reshape(B, S, 3, H, Dh), 2, 0, 3, 1, 4)
        q, k, v = qkv[0], qkv[1], qkv[2]
        scores = torch.einsum("bhqd,bhkd->bhqk", q, k) * (Dh ** -0.5)
        p = _softmax(scores, axis=-1)
        o = torch.einsum("bhqk,bhkd->bhqd", p, v)
        return (lambda x, *d: x.permute(*d))(o, 0, 2, 1, 3).reshape(B, S, D) @ wo

    a = _A_ref(A_x, A_wqkv, A_wo)
    b = _B_ref(B_x, B_wqkv, B_wo)
    return torch.concatenate([a, b], axis=-1)
```

```asm
; @launch grid=(256,1,1) block=(768,1,1) lds=163840
.amdgcn_target "amdgcn-amd-amdhsa--gfx950"
.text
.globl concat_heads__sliding_local_dilated__mha_block__prompt_kernel
.p2align 8
.type concat_heads__sliding_local_dilated__mha_block__prompt_kernel,@function
concat_heads__sliding_local_dilated__mha_block__prompt_kernel:
L_begin:
    s_load_dwordx16 s[64:79], s[0:1], 0
    s_load_dwordx2 s[80:81], s[0:1], 64
    s_memrealtime s[32:33]
    s_cmp_ge_u32 s2, 256
    s_cbranch_scc1 L_exit
    v_lshrrev_b32 v1, 6, v0
    v_and_b32 v0, 63, v0
    v_readfirstlane_b32 s3, v1
    s_and_b32 s51, s2, 7
    s_lshr_b32 s52, s2, 3
    s_mul_i32 s53, s51, 31
    s_add_u32 s53, s53, s52
    s_cmp_lt_u32 s52, 31
    s_cselect_b32 s42, 1, 0
    s_cmp_lt_u32 s53, 242
    s_cselect_b32 s42, s42, 0
    s_mul_i32 s38, s53, 171
    s_lshr_b32 s38, s38, 10
    s_mul_i32 s39, s38, 6
    s_sub_u32 s39, s53, s39
    s_sub_u32 s54, s53, 132
    s_mul_i32 s55, s54, 205
    s_lshr_b32 s55, s55, 10
    s_mul_i32 s56, s55, 5
    s_sub_u32 s56, s54, s56
    s_add_u32 s56, s56, 6
    s_cmp_ge_u32 s53, 132
    s_cselect_b32 s38, s55, s38
    s_cselect_b32 s39, s56, s39
    s_mul_i32 s40, s38, 96
    s_min_u32 s40, s40, 1952
    s_lshl_b32 s41, s39, 2
    s_min_u32 s41, s41, 38
    s_sub_u32 s3, s3, 4
    s_cselect_b32 s51, 12, 0
    s_add_u32 s3, s3, s51
    s_and_b32 s50, s3, 3
    s_cmp_ge_u32 s3, 8
    s_cbranch_scc0 L_comp
    s_setprio 3
    v_lshrrev_b32 v1, 3, v0
    v_and_b32 v2, 7, v0
    v_lshrrev_b32 v3, 1, v1
    s_and_b32 s51, s3, 1
    s_lshl_b32 s51, s51, 2
    v_add_u32 v4, s51, v3
    v_xor_b32 v4, v2, v4
    v_lshlrev_b32 v4, 4, v4
    v_mul_u32_u24 v5, 896, v1
    v_add_u32 v8, v4, v5
    v_add_u32 v9, 28672, v8
    v_add_u32 v10, 57344, v8
    v_and_b32 v3, 1, v3
    v_lshlrev_b32 v3, 2, v3
    v_xor_b32 v4, v2, v3
    v_lshlrev_b32 v4, 4, v4
    v_add_u32 v161, v4, v5
    v_mul_u32_u24 v5, 2688, v1
    v_add_u32 v11, v4, v5
    v_add_u32 v12, 86016, v11
    v_add_u32 v13, 128, v11
    v_add_u32 v14, 128, v12
    s_lshl_b32 s51, s50, 3
    s_add_u32 s56, s40, s51
    s_mul_i32 s56, s56, 896
    s_mul_i32 s57, s51, 2688
    s_lshl_b32 s52, s41, 6
    s_add_u32 s57, s57, s52
    s_lshl_b32 s58, s50, 10
    s_add_u32 s59, s38, s39
    s_mul_i32 s51, s59, 37
    s_lshr_b32 s51, s51, 8
    s_mul_i32 s51, s51, 7
    s_sub_u32 s59, s59, s51
    s_waitcnt lgkmcnt(0)
    s_mov_b32 s4, s70
    s_mov_b32 s5, s71
    s_mov_b32 s6, 1835008
    s_mov_b32 s7, 0x20000
    s_mov_b32 s8, s72
    s_mov_b32 s9, s73
    s_mov_b32 s10, 1204224
    s_mov_b32 s11, 0x20000
    s_cmp_eq_u32 s42, 0
    s_cbranch_scc1 L_sv_nog
    s_lshl_b32 s60, s59, 7
    s_add_u32 s60, s60, s56
    s_mul_i32 s61, s59, 172032
    s_add_u32 s61, s61, s57
    s_add_u32 m0, s58, 0
    s_add_u32 s59, s59, 1
    buffer_load_dwordx4 v8, s[4:7], s60 offen  lds
    s_add_u32 m0, s58, 12288
    s_nop 0
    buffer_load_dwordx4 v11, s[8:11], s61 offen  lds
    s_add_u32 m0, s58, 20480
    s_nop 0
    buffer_load_dwordx4 v13, s[8:11], s61 offen  lds
    s_add_u32 m0, s58, 4096
    s_nop 0
    buffer_load_dwordx4 v9, s[4:7], s60 offen  lds
    s_add_u32 m0, s58, 16384
    s_nop 0
    buffer_load_dwordx4 v12, s[8:11], s61 offen  lds
    s_add_u32 m0, s58, 24576
    s_nop 0
    buffer_load_dwordx4 v14, s[8:11], s61 offen  lds
    s_add_u32 m0, s58, 8192
    s_cmp_ge_u32 s59, 7
    buffer_load_dwordx4 v10, s[4:7], s60 offen  lds
    s_cselect_b32 s59, 0, s59
    s_mov_b32 s12, s64
    s_mov_b32 s13, s65
    s_mov_b32 s14, 1835008
    s_mov_b32 s15, 0x20000
    s_mov_b32 s16, s66
    s_mov_b32 s17, s67
    s_mov_b32 s18, 1204224
    s_mov_b32 s19, 0x20000
    s_mov_b32 s20, s80
    s_mov_b32 s21, s81
    s_mov_b32 s22, 15679488
    s_mov_b32 s23, 0x20000
    s_mov_b32 s28, s78
    s_mov_b32 s29, s79
    s_mov_b32 s30, 256
    s_mov_b32 s31, 0x20000
    s_mov_b32 s24, s76
    s_mov_b32 s25, s77
    s_mov_b32 s26, 3670016
    s_mov_b32 s27, 0x20000
    s_sub_u32 s51, s3, 8
    s_or_b32 s51, s51, s2
    s_cmp_eq_u32 s51, 0
    s_cbranch_scc0 L_nonon
    v_mov_b32 v18, 0
    v_mov_b32 v19, 0
    s_or_b32 s53, s33, 0x80000000
    v_mov_b32 v16, s32
    v_mov_b32 v17, s53
    s_mov_b64 exec, 1
    buffer_atomic_cmpswap_x2 v[16:19], v18, s[28:31], 0 offen sc1
    s_mov_b64 exec, -1
    s_nop 1
L_nonon:
    s_lshl_b32 s60, s59, 7
    s_add_u32 s60, s60, s56
    s_mul_i32 s61, s59, 172032
    s_add_u32 s61, s61, s57
    s_add_u32 m0, s58, 28672
    s_add_u32 s59, s59, 1
    buffer_load_dwordx4 v8, s[4:7], s60 offen  lds
    s_add_u32 m0, s58, 40960
    s_nop 0
    buffer_load_dwordx4 v11, s[8:11], s61 offen  lds
    s_add_u32 m0, s58, 49152
    s_nop 0
    buffer_load_dwordx4 v13, s[8:11], s61 offen  lds
    s_add_u32 m0, s58, 32768
    s_nop 0
    buffer_load_dwordx4 v9, s[4:7], s60 offen  lds
    s_add_u32 m0, s58, 45056
    s_nop 0
    buffer_load_dwordx4 v12, s[8:11], s61 offen  lds
    s_add_u32 m0, s58, 53248
    s_nop 0
    buffer_load_dwordx4 v14, s[8:11], s61 offen  lds
    s_add_u32 m0, s58, 36864
    s_cmp_ge_u32 s59, 7
    buffer_load_dwordx4 v10, s[4:7], s60 offen  lds
    s_cselect_b32 s59, 0, s59
    s_waitcnt vmcnt(7)
    s_barrier
    s_lshl_b32 s60, s59, 7
    s_add_u32 s60, s60, s56
    s_mul_i32 s61, s59, 172032
    s_add_u32 s61, s61, s57
    s_add_u32 m0, s58, 57344
    s_add_u32 s59, s59, 1
    buffer_load_dwordx4 v8, s[4:7], s60 offen  lds
    s_add_u32 m0, s58, 69632
    s_nop 0
    buffer_load_dwordx4 v11, s[8:11], s61 offen  lds
    s_add_u32 m0, s58, 77824
    s_nop 0
    buffer_load_dwordx4 v13, s[8:11], s61 offen  lds
    s_add_u32 m0, s58, 61440
    s_nop 0
    buffer_load_dwordx4 v9, s[4:7], s60 offen  lds
    s_add_u32 m0, s58, 73728
    s_nop 0
    buffer_load_dwordx4 v12, s[8:11], s61 offen  lds
    s_add_u32 m0, s58, 81920
    s_nop 0
    buffer_load_dwordx4 v14, s[8:11], s61 offen  lds
    s_add_u32 m0, s58, 65536
    s_cmp_ge_u32 s59, 7
    buffer_load_dwordx4 v10, s[4:7], s60 offen  lds
    s_cselect_b32 s59, 0, s59
    s_lshl_b32 s60, s59, 7
    s_add_u32 s60, s60, s56
    s_mul_i32 s61, s59, 172032
    s_add_u32 s61, s61, s57
    s_add_u32 m0, s58, 86016
    s_add_u32 s59, s59, 1
    buffer_load_dwordx4 v8, s[4:7], s60 offen  lds
    s_add_u32 m0, s58, 98304
    s_nop 0
    buffer_load_dwordx4 v11, s[8:11], s61 offen  lds
    s_add_u32 m0, s58, 106496
    s_nop 0
    buffer_load_dwordx4 v13, s[8:11], s61 offen  lds
    s_add_u32 m0, s58, 90112
    s_nop 0
    buffer_load_dwordx4 v9, s[4:7], s60 offen  lds
    s_add_u32 m0, s58, 102400
    s_nop 0
    buffer_load_dwordx4 v12, s[8:11], s61 offen  lds
    s_add_u32 m0, s58, 110592
    s_nop 0
    buffer_load_dwordx4 v14, s[8:11], s61 offen  lds
    s_add_u32 m0, s58, 94208
    s_cmp_ge_u32 s59, 7
    buffer_load_dwordx4 v10, s[4:7], s60 offen  lds
    s_cselect_b32 s59, 0, s59
    s_waitcnt vmcnt(14)
    s_barrier
    s_lshl_b32 s60, s59, 7
    s_add_u32 s60, s60, s56
    s_mul_i32 s61, s59, 172032
    s_add_u32 s61, s61, s57
    s_add_u32 m0, s58, 0
    s_add_u32 s59, s59, 1
    buffer_load_dwordx4 v8, s[4:7], s60 offen  lds
    s_add_u32 m0, s58, 12288
    s_nop 0
    buffer_load_dwordx4 v11, s[8:11], s61 offen  lds
    s_add_u32 m0, s58, 20480
    s_nop 0
    buffer_load_dwordx4 v13, s[8:11], s61 offen  lds
    s_add_u32 m0, s58, 4096
    s_nop 0
    buffer_load_dwordx4 v9, s[4:7], s60 offen  lds
    s_add_u32 m0, s58, 16384
    s_nop 0
    buffer_load_dwordx4 v12, s[8:11], s61 offen  lds
    s_add_u32 m0, s58, 24576
    s_nop 0
    buffer_load_dwordx4 v14, s[8:11], s61 offen  lds
    s_add_u32 m0, s58, 8192
    s_cmp_ge_u32 s59, 7
    buffer_load_dwordx4 v10, s[4:7], s60 offen  lds
    s_cselect_b32 s59, 0, s59
    s_waitcnt vmcnt(14)
    s_barrier
    s_lshl_b32 s60, s59, 7
    s_add_u32 s60, s60, s56
    s_mul_i32 s61, s59, 172032
    s_add_u32 s61, s61, s57
    s_add_u32 m0, s58, 28672
    s_add_u32 s59, s59, 1
    buffer_load_dwordx4 v8, s[4:7], s60 offen  lds
    s_add_u32 m0, s58, 40960
    s_nop 0
    buffer_load_dwordx4 v11, s[8:11], s61 offen  lds
    s_add_u32 m0, s58, 49152
    s_nop 0
    buffer_load_dwordx4 v13, s[8:11], s61 offen  lds
    s_add_u32 m0, s58, 32768
    s_nop 0
    buffer_load_dwordx4 v9, s[4:7], s60 offen  lds
    s_add_u32 m0, s58, 45056
    s_nop 0
    buffer_load_dwordx4 v12, s[8:11], s61 offen  lds
    s_add_u32 m0, s58, 53248
    s_nop 0
    buffer_load_dwordx4 v14, s[8:11], s61 offen  lds
    s_add_u32 m0, s58, 36864
    s_cmp_ge_u32 s59, 7
    buffer_load_dwordx4 v10, s[4:7], s60 offen  lds
    s_cselect_b32 s59, 0, s59
    s_waitcnt vmcnt(14)
    s_barrier
    s_cmp_eq_u32 s50, 0
    s_cbranch_scc0 L_t1a
    s_mul_i32 s51, s39, 7936
    s_mul_i32 s52, s40, 896
    s_add_u32 s51, s51, s52
    v_min_u32 v15, 61, v0
    v_lshl_add_u32 v15, v15, 7, s51
    buffer_load_dword v156, v15, s[12:15], 0 offen
L_t1a:
    s_cmp_eq_u32 s50, 1
    s_cbranch_scc0 L_t2a
    s_mul_i32 s51, s38, 56448
    s_lshl_b32 s52, s41, 6
    s_add_u32 s51, s51, s52
    v_min_u32 v15, 41, v0
    v_lshrrev_b32 v157, 1, v15
    v_mul_u32_u24 v157, 2688, v157
    v_and_b32 v15, 1, v15
    v_lshl_add_u32 v15, v15, 7, v157
    v_add_u32 v15, s51, v15
    buffer_load_dword v156, v15, s[16:19], 0 offen
L_t2a:
    s_lshl_b32 s60, s59, 7
    s_add_u32 s60, s60, s56
    s_mul_i32 s61, s59, 172032
    s_add_u32 s61, s61, s57
    s_add_u32 m0, s58, 57344
    s_add_u32 s59, s59, 1
    buffer_load_dwordx4 v8, s[4:7], s60 offen  lds
    s_add_u32 m0, s58, 69632
    s_nop 0
    buffer_load_dwordx4 v11, s[8:11], s61 offen  lds
    s_add_u32 m0, s58, 77824
    s_nop 0
    buffer_load_dwordx4 v13, s[8:11], s61 offen  lds
    s_add_u32 m0, s58, 61440
    s_nop 0
    buffer_load_dwordx4 v9, s[4:7], s60 offen  lds
    s_add_u32 m0, s58, 73728
    s_nop 0
    buffer_load_dwordx4 v12, s[8:11], s61 offen  lds
    s_add_u32 m0, s58, 81920
    s_nop 0
    buffer_load_dwordx4 v14, s[8:11], s61 offen  lds
    s_add_u32 m0, s58, 65536
    s_cmp_ge_u32 s59, 7
    buffer_load_dwordx4 v10, s[4:7], s60 offen  lds
    s_cselect_b32 s59, 0, s59
    s_waitcnt vmcnt(14)
    s_barrier
    s_add_u32 s59, s38, s39
    s_mul_i32 s51, s59, 86
    s_lshr_b32 s51, s51, 8
    s_mul_i32 s51, s51, 3
    s_sub_u32 s59, s59, s51
    s_lshl_b32 s59, s59, 1
    s_lshl_b32 s60, s59, 7
    s_add_u32 s60, s60, s56
    s_mul_i32 s61, s59, 172032
    s_add_u32 s61, s61, s57
    s_add_u32 m0, s58, 86016
    s_add_u32 s59, s59, 1
    buffer_load_dwordx4 v8, s[12:15], s60 offen  lds
    s_add_u32 m0, s58, 98304
    s_nop 0
    buffer_load_dwordx4 v11, s[16:19], s61 offen  lds
    s_add_u32 m0, s58, 106496
    s_nop 0
    buffer_load_dwordx4 v13, s[16:19], s61 offen  lds
    s_add_u32 m0, s58, 90112
    s_nop 0
    buffer_load_dwordx4 v9, s[12:15], s60 offen  lds
    s_add_u32 m0, s58, 102400
    s_nop 0
    buffer_load_dwordx4 v12, s[16:19], s61 offen  lds
    s_add_u32 m0, s58, 110592
    s_nop 0
    buffer_load_dwordx4 v14, s[16:19], s61 offen  lds
    s_add_u32 m0, s58, 94208
    s_cmp_ge_u32 s59, 7
    buffer_load_dwordx4 v10, s[12:15], s60 offen  lds
    s_cselect_b32 s59, 0, s59
    s_waitcnt vmcnt(14)
    s_barrier
    s_lshl_b32 s60, s59, 7
    s_add_u32 s60, s60, s56
    s_mul_i32 s61, s59, 172032
    s_add_u32 s61, s61, s57
    s_add_u32 m0, s58, 0
    s_add_u32 s59, s59, 1
    buffer_load_dwordx4 v8, s[12:15], s60 offen  lds
    s_add_u32 m0, s58, 12288
    s_nop 0
    buffer_load_dwordx4 v11, s[16:19], s61 offen  lds
    s_add_u32 m0, s58, 20480
    s_nop 0
    buffer_load_dwordx4 v13, s[16:19], s61 offen  lds
    s_add_u32 m0, s58, 4096
    s_nop 0
    buffer_load_dwordx4 v9, s[12:15], s60 offen  lds
    s_add_u32 m0, s58, 16384
    s_nop 0
    buffer_load_dwordx4 v12, s[16:19], s61 offen  lds
    s_add_u32 m0, s58, 24576
    s_nop 0
    buffer_load_dwordx4 v14, s[16:19], s61 offen  lds
    s_add_u32 m0, s58, 8192
    s_cmp_ge_u32 s59, 7
    buffer_load_dwordx4 v10, s[12:15], s60 offen  lds
    s_cselect_b32 s59, 0, s59
    s_waitcnt vmcnt(14)
    s_barrier
    s_lshl_b32 s60, s59, 7
    s_add_u32 s60, s60, s56
    s_mul_i32 s61, s59, 172032
    s_add_u32 s61, s61, s57
    s_add_u32 m0, s58, 28672
    s_add_u32 s59, s59, 1
    buffer_load_dwordx4 v8, s[12:15], s60 offen  lds
    s_add_u32 m0, s58, 40960
    s_nop 0
    buffer_load_dwordx4 v11, s[16:19], s61 offen  lds
    s_add_u32 m0, s58, 49152
    s_nop 0
    buffer_load_dwordx4 v13, s[16:19], s61 offen  lds
    s_add_u32 m0, s58, 32768
    s_nop 0
    buffer_load_dwordx4 v9, s[12:15], s60 offen  lds
    s_add_u32 m0, s58, 45056
    s_nop 0
    buffer_load_dwordx4 v12, s[16:19], s61 offen  lds
    s_add_u32 m0, s58, 53248
    s_nop 0
    buffer_load_dwordx4 v14, s[16:19], s61 offen  lds
    s_add_u32 m0, s58, 36864
    s_cmp_ge_u32 s59, 7
    buffer_load_dwordx4 v10, s[12:15], s60 offen  lds
    s_cselect_b32 s59, 0, s59
    s_waitcnt vmcnt(14)
    s_barrier
    s_lshl_b32 s60, s59, 7
    s_add_u32 s60, s60, s56
    s_mul_i32 s61, s59, 172032
    s_add_u32 s61, s61, s57
    s_add_u32 m0, s58, 57344
    s_add_u32 s59, s59, 1
    buffer_load_dwordx4 v8, s[12:15], s60 offen  lds
    s_add_u32 m0, s58, 69632
    s_nop 0
    buffer_load_dwordx4 v11, s[16:19], s61 offen  lds
    s_add_u32 m0, s58, 77824
    s_nop 0
    buffer_load_dwordx4 v13, s[16:19], s61 offen  lds
    s_add_u32 m0, s58, 61440
    s_nop 0
    buffer_load_dwordx4 v9, s[12:15], s60 offen  lds
    s_add_u32 m0, s58, 73728
    s_nop 0
    buffer_load_dwordx4 v12, s[16:19], s61 offen  lds
    s_add_u32 m0, s58, 81920
    s_nop 0
    buffer_load_dwordx4 v14, s[16:19], s61 offen  lds
    s_add_u32 m0, s58, 65536
    s_cmp_ge_u32 s59, 7
    buffer_load_dwordx4 v10, s[12:15], s60 offen  lds
    s_cselect_b32 s59, 0, s59
    s_and_b32 s51, s2, 7
    s_lshl_b32 s34, s51, 1
    s_bfe_u32 s36, s2, 0x10003
    s_add_u32 s34, s34, s36
    s_lshr_b32 s35, s2, 4
    s_mul_i32 s37, s34, 7
    s_lshr_b32 s37, s37, 1
    s_lshl_b32 s37, s37, 9
    s_lshr_b32 s52, s2, 3
    s_cmp_lt_u32 s52, 28
    s_cselect_b32 s45, 1, 0
    s_mul_i32 s43, s52, 37
    s_lshr_b32 s43, s43, 8
    s_mul_i32 s53, s43, 7
    s_sub_u32 s44, s52, s53
    s_lshl_b32 s51, s51, 2
    s_add_u32 s43, s43, s51
    s_min_u32 s43, s43, 31
    s_cmp_eq_u32 s36, 0
    s_cselect_b32 s46, 0x0fffffff, -16
    s_mov_b32 s47, s46
    s_cselect_b32 s48, 0, -1
    s_cselect_b32 s49, -1, 0
    v_and_b32 v1, 31, v0
    v_lshrrev_b32 v2, 5, v0
    v_and_b32 v3, 51, v0
    v_bfe_u32 v4, v0, 2, 1
    v_lshl_add_u32 v3, v4, 3, v3
    v_bfe_u32 v4, v0, 3, 1
    v_lshl_add_u32 v3, v4, 2, v3
    v_lshlrev_b32 v5, 4, v3
    v_lshlrev_b32 v6, 4, v0
    s_mov_b32 s64, s48
    s_mov_b32 s65, s48
    s_mov_b32 s66, s48
    s_mov_b32 s67, 0
    s_mov_b32 s70, 0
    s_mov_b32 s71, s49
    v_mov_b32 v160, 0
    v_mov_b32 v138, 0
    v_mov_b32 v139, 0
    v_mul_u32_u24 v7, 448, v2
    v_lshl_add_u32 v7, v1, 4, v7
    s_lshl_b32 s51, s36, 6
    s_sub_u32 s51, 256, s51
    v_add_u32 v162, s51, v7
    v_subrev_u32 v163, 128, v162
    v_lshlrev_b32 v164, 12, v0
    v_add_u32 v164, 147456, v164
    s_lshl_b32 s51, s50, 12
    s_add_u32 s51, s51, 147456
    v_mov_b32 v167, s51
    v_mov_b32 v7, 0
    ds_write_b32 v167, v7
    s_lshl_b32 s51, s35, 2
    s_add_u32 s51, s51, s50
    v_lshlrev_b32 v7, 3, v2
    v_sub_u32 v7, v1, v7
    v_add_u32 v7, 18, v7
    v_mov_b32 v126, 0x5555
    v_mov_b32 v127, 0
    v_lshlrev_b64 v[126:127], v7, v[126:127]
    s_cmp_eq_u32 s51, 0
    s_cselect_b32 s52, 0, -1
    v_and_b32 v126, s52, v126
    v_not_b32 v126, v126
    v_not_b32 v127, v127
    s_mov_b32 s52, 0xf149f2ca
    v_mov_b32 v124, 0xdddddddd
    v_bfe_i32 v32, v127, 0, 1
    v_and_b32 v32, s52, v32
    v_mov_b32 v16, 0
    v_mov_b32 v48, 0
    v_bfe_i32 v33, v127, 1, 1
    v_and_b32 v33, s52, v33
    v_mov_b32 v17, 0
    v_mov_b32 v49, 0
    v_bfe_i32 v34, v127, 2, 1
    v_and_b32 v34, s52, v34
    v_mov_b32 v18, 0
    v_mov_b32 v50, 0
    v_bfe_i32 v35, v127, 3, 1
    v_and_b32 v35, s52, v35
    v_mov_b32 v19, 0
    v_mov_b32 v51, 0
    v_bfe_i32 v36, v127, 4, 1
    v_and_b32 v36, s52, v36
    v_mov_b32 v20, 0
    v_mov_b32 v52, 0
    v_bfe_i32 v37, v127, 5, 1
    v_and_b32 v37, s52, v37
    v_mov_b32 v21, 0
    v_mov_b32 v53, 0
    v_bfe_i32 v38, v127, 6, 1
    v_and_b32 v38, s52, v38
    v_mov_b32 v22, 0
    v_mov_b32 v54, 0
    v_bfe_i32 v39, v127, 7, 1
    v_and_b32 v39, s52, v39
    v_mov_b32 v23, 0
    v_mov_b32 v55, 0
    v_bfe_i32 v40, v127, 16, 1
    v_and_b32 v40, s52, v40
    v_bfe_i32 v24, v126, 16, 1
    v_and_b32 v24, s52, v24
    v_mov_b32 v56, 0
    v_bfe_i32 v41, v127, 17, 1
    v_and_b32 v41, s52, v41
    v_bfe_i32 v25, v126, 17, 1
    v_and_b32 v25, s52, v25
    v_mov_b32 v57, 0
    v_bfe_i32 v42, v127, 18, 1
    v_and_b32 v42, s52, v42
    v_bfe_i32 v26, v126, 18, 1
    v_and_b32 v26, s52, v26
    v_mov_b32 v58, 0
    v_bfe_i32 v43, v127, 19, 1
    v_and_b32 v43, s52, v43
    v_bfe_i32 v27, v126, 19, 1
    v_and_b32 v27, s52, v27
    v_mov_b32 v59, 0
    v_bfe_i32 v44, v127, 20, 1
    v_and_b32 v44, s52, v44
    v_bfe_i32 v28, v126, 20, 1
    v_and_b32 v28, s52, v28
    v_mov_b32 v60, 0
    v_bfe_i32 v45, v127, 21, 1
    v_and_b32 v45, s52, v45
    v_bfe_i32 v29, v126, 21, 1
    v_and_b32 v29, s52, v29
    v_mov_b32 v61, 0
    v_bfe_i32 v46, v127, 22, 1
    v_and_b32 v46, s52, v46
    v_bfe_i32 v30, v126, 22, 1
    v_and_b32 v30, s52, v30
    v_mov_b32 v62, 0
    v_bfe_i32 v47, v127, 23, 1
    v_and_b32 v47, s52, v47
    v_bfe_i32 v31, v126, 23, 1
    v_and_b32 v31, s52, v31
    v_mov_b32 v63, 0
    v_mov_b32 v112, 0x3f803f80
    v_mov_b32 v113, 0x3f803f80
    v_mov_b32 v114, 0x3f803f80
    v_mov_b32 v115, 0x3f803f80
    v_mov_b32 v116, 0x3f803f80
    v_mov_b32 v117, 0x3f803f80
    v_mov_b32 v118, 0x3f803f80
    v_mov_b32 v119, 0x3f803f80
    v_mov_b32 v120, 0x3f803f80
    v_mov_b32 v121, 0x3f803f80
    v_mov_b32 v122, 0x3f803f80
    v_mov_b32 v123, 0x3f803f80
    v_mov_b32 v140, 0x3e8b97f6
    v_mov_b32 v128, -1
    v_mov_b32 v129, -1
    v_mov_b32 v130, -1
    v_mov_b32 v131, -1
    v_and_b32 v7, 31, v3
    s_lshl_b32 s53, s36, 2
    v_subrev_u32 v7, s53, v7
    v_cmp_gt_u32 s[72:73], 28, v7
    v_mul_u32_u24 v125, 448, v2
    v_lshl_add_u32 v125, v7, 4, v125
    v_add_u32 v125, 256, v125
    s_mov_b64 s[76:77], s[56:57]
    s_mov_b32 s78, s58
    s_and_b32 s55, s50, 1
    s_lshl_b32 s52, s43, 1
    s_add_u32 s55, s55, s52
    s_lshr_b32 s51, s50, 1
    s_lshl_b32 s52, s55, 15
    s_lshl_b32 s53, s51, 14
    s_add_u32 s52, s52, s53
    s_add_u32 s52, s52, 11010048
    s_mul_i32 s55, s55, 57344
    s_lshl_b32 s53, s44, 7
    s_add_u32 s55, s55, s53
    s_lshl_b32 s53, s51, 6
    s_add_u32 s55, s55, s53
    s_add_u32 s55, s55, 0
    s_lshl_b32 s53, s50, 12
    s_xor_b32 s54, s53, 0x2000
    s_add_u32 s53, s53, 147456
    s_add_u32 s54, s54, 147456
    s_mul_i32 s57, s51, 28672
    s_add_u32 s57, s57, 57344
    s_lshl_b32 s58, s50, 2
    s_add_u32 s58, s58, 131072
    v_lshrrev_b32 v7, 5, v0
    v_bfe_u32 v4, v0, 2, 2
    v_lshl_add_u32 v144, v7, 3, v4
    v_lshlrev_b32 v144, 7, v144
    v_lshrrev_b32 v4, 1, v4
    v_xor_b32 v4, 0, v4
    v_lshl_add_u32 v144, v4, 6, v144
    v_bfe_u32 v4, v0, 4, 1
    v_lshl_add_u32 v144, v4, 5, v144
    v_and_b32 v4, 1, v0
    v_lshl_add_u32 v144, v4, 4, v144
    v_bfe_u32 v4, v0, 1, 1
    v_lshl_add_u32 v144, v4, 3, v144
    v_add_u32 v144, s57, v144
    v_xor_b32 v145, 64, v144
    v_add_u32 v146, s53, v6
    v_add_u32 v147, s54, v6
    v_mov_b32 v148, s58
    v_xor_b32 v149, 8, v148
    v_mov_b32 v150, 1
    v_mul_u32_u24 v151, 1792, v1
    v_lshl_add_u32 v151, v2, 4, v151
    v_add_u32 v152, 0x1000, v6
    v_add_u32 v153, 0x2000, v6
    v_add_u32 v154, 0x3000, v6
    s_mov_b64 s[56:57], s[76:77]
    s_mov_b32 s58, s78
    s_waitcnt lgkmcnt(0)
    s_waitcnt vmcnt(14)
    s_barrier
    s_lshl_b32 s60, s59, 7
    s_add_u32 s60, s60, s56
    s_mul_i32 s61, s59, 172032
    s_add_u32 s61, s61, s57
    s_add_u32 m0, s58, 86016
    s_add_u32 s59, s59, 1
    buffer_load_dwordx4 v8, s[12:15], s60 offen  lds
    s_add_u32 m0, s58, 98304
    s_nop 0
    buffer_load_dwordx4 v11, s[16:19], s61 offen  lds
    s_add_u32 m0, s58, 106496
    s_nop 0
    buffer_load_dwordx4 v13, s[16:19], s61 offen  lds
    s_add_u32 m0, s58, 90112
    s_nop 0
    buffer_load_dwordx4 v9, s[12:15], s60 offen  lds
    s_add_u32 m0, s58, 102400
    s_nop 0
    buffer_load_dwordx4 v12, s[16:19], s61 offen  lds
    s_add_u32 m0, s58, 110592
    s_nop 0
    buffer_load_dwordx4 v14, s[16:19], s61 offen  lds
    s_add_u32 m0, s58, 94208
    s_cmp_ge_u32 s59, 7
    buffer_load_dwordx4 v10, s[12:15], s60 offen  lds
    s_cselect_b32 s59, 0, s59
    s_waitcnt vmcnt(14)
    s_barrier
    s_lshl_b32 s60, s59, 7
    s_add_u32 s60, s60, s56
    s_mul_i32 s61, s59, 172032
    s_add_u32 s61, s61, s57
    s_add_u32 m0, s58, 0
    s_add_u32 s59, s59, 1
    buffer_load_dwordx4 v8, s[12:15], s60 offen  lds
    s_add_u32 m0, s58, 12288
    s_nop 0
    buffer_load_dwordx4 v11, s[16:19], s61 offen  lds
    s_add_u32 m0, s58, 20480
    s_nop 0
    buffer_load_dwordx4 v13, s[16:19], s61 offen  lds
    s_add_u32 m0, s58, 4096
    s_nop 0
    buffer_load_dwordx4 v9, s[12:15], s60 offen  lds
    s_add_u32 m0, s58, 16384
    s_nop 0
    buffer_load_dwordx4 v12, s[16:19], s61 offen  lds
    s_add_u32 m0, s58, 24576
    s_nop 0
    buffer_load_dwordx4 v14, s[16:19], s61 offen  lds
    s_add_u32 m0, s58, 8192
    s_cmp_ge_u32 s59, 7
    buffer_load_dwordx4 v10, s[12:15], s60 offen  lds
    s_cselect_b32 s59, 0, s59
    s_waitcnt vmcnt(14)
    s_barrier
    s_lshl_b32 s60, s59, 7
    s_add_u32 s60, s60, s56
    s_mul_i32 s61, s59, 172032
    s_add_u32 s61, s61, s57
    s_add_u32 m0, s58, 28672
    s_add_u32 s59, s59, 1
    buffer_load_dwordx4 v8, s[12:15], s60 offen  lds
    s_add_u32 m0, s58, 40960
    s_nop 0
    buffer_load_dwordx4 v11, s[16:19], s61 offen  lds
    s_add_u32 m0, s58, 49152
    s_nop 0
    buffer_load_dwordx4 v13, s[16:19], s61 offen  lds
    s_add_u32 m0, s58, 32768
    s_nop 0
    buffer_load_dwordx4 v9, s[12:15], s60 offen  lds
    s_add_u32 m0, s58, 45056
    s_nop 0
    buffer_load_dwordx4 v12, s[16:19], s61 offen  lds
    s_add_u32 m0, s58, 53248
    s_nop 0
    buffer_load_dwordx4 v14, s[16:19], s61 offen  lds
    s_add_u32 m0, s58, 36864
    s_cmp_ge_u32 s59, 7
    buffer_load_dwordx4 v10, s[12:15], s60 offen  lds
    s_cselect_b32 s59, 0, s59
    s_mov_b32 s4, s68
    s_mov_b32 s5, s69
    s_mov_b32 s6, 401408
    s_mov_b32 s7, 0x20000
    s_mov_b32 s8, s74
    s_mov_b32 s9, s75
    s_mov_b32 s10, 401408
    s_mov_b32 s11, 0x20000
    s_lshl_b32 s58, s50, 12
    s_mul_i32 s59, s50, 28672
    s_add_u32 s59, s59, s37
    s_add_u32 s59, s59, 1835008
    s_lshl_b32 s60, s34, 6
    s_add_u32 s60, s60, s50
    s_mul_i32 s60, s60, 1792
    s_add_u32 s60, s60, 3669760
    s_waitcnt vmcnt(14)
    s_barrier
    buffer_load_dwordx2 v[158:159], v160, s[28:31], 0 offen sc1
    s_cmp_eq_u32 s50, 0
    s_cbranch_scc1 L_fu0
    buffer_load_dwordx2 v[158:159], v160, s[28:31], 0 offen sc1
    buffer_load_dwordx2 v[158:159], v160, s[28:31], 0 offen sc1
    buffer_load_dwordx2 v[158:159], v160, s[28:31], 0 offen sc1
    s_branch L_fud0
L_fu0:
    s_lshr_b32 s51, s37, 11
    s_add_u32 s52, s37, 1536
    s_lshr_b32 s52, s52, 11
    s_sub_u32 s52, s52, s51
    s_lshl_b32 s52, s52, 12
    v_mul_u32_u24 v7, s52, v2
    s_lshl_b32 s51, s51, 12
    s_add_u32 s79, s51, 15204352
    s_lshl_b32 s51, s35, 2
    s_add_u32 s52, s51, 3
    s_mul_i32 s51, s51, 86
    s_lshr_b32 s51, s51, 8
    s_mul_i32 s52, s52, 86
    s_lshr_b32 s52, s52, 8
    v_max_u32 v4, s51, v1
    v_min_u32 v4, s52, v4
    v_lshl_add_u32 v139, v4, 7, v7
    v_min_u32 v4, 21, v1
    v_lshl_add_u32 v138, v4, 7, v7
    v_add_u32 v138, 57344, v138
    s_add_u32 s80, s79, 57344
    buffer_load_dwordx2 v[132:133], v139, s[20:23], s79 offen sc1
    buffer_load_dwordx2 v[134:135], v138, s[20:23], s79 offen sc1
    buffer_load_dwordx2 v[136:137], v138, s[20:23], s80 offen sc1
L_fud0:
    s_waitcnt vmcnt(11)
    s_barrier
    s_waitcnt vmcnt(4)
    s_barrier
    s_waitcnt vmcnt(0)
    s_branch L_sv_att
L_sv_nog:
    s_mov_b32 s20, s80
    s_mov_b32 s21, s81
    s_mov_b32 s22, 15679488
    s_mov_b32 s23, 0x20000
    s_mov_b32 s28, s78
    s_mov_b32 s29, s79
    s_mov_b32 s30, 256
    s_mov_b32 s31, 0x20000
    s_mov_b32 s24, s76
    s_mov_b32 s25, s77
    s_mov_b32 s26, 3670016
    s_mov_b32 s27, 0x20000
    s_and_b32 s51, s2, 7
    s_lshl_b32 s34, s51, 1
    s_bfe_u32 s36, s2, 0x10003
    s_add_u32 s34, s34, s36
    s_lshr_b32 s35, s2, 4
    s_mul_i32 s37, s34, 7
    s_lshr_b32 s37, s37, 1
    s_lshl_b32 s37, s37, 9
    s_lshr_b32 s52, s2, 3
    s_cmp_lt_u32 s52, 28
    s_cselect_b32 s45, 1, 0
    s_mul_i32 s43, s52, 37
    s_lshr_b32 s43, s43, 8
    s_mul_i32 s53, s43, 7
    s_sub_u32 s44, s52, s53
    s_lshl_b32 s51, s51, 2
    s_add_u32 s43, s43, s51
    s_min_u32 s43, s43, 31
    s_cmp_eq_u32 s36, 0
    s_cselect_b32 s46, 0x0fffffff, -16
    s_mov_b32 s47, s46
    s_cselect_b32 s48, 0, -1
    s_cselect_b32 s49, -1, 0
    v_and_b32 v1, 31, v0
    v_lshrrev_b32 v2, 5, v0
    v_and_b32 v3, 51, v0
    v_bfe_u32 v4, v0, 2, 1
    v_lshl_add_u32 v3, v4, 3, v3
    v_bfe_u32 v4, v0, 3, 1
    v_lshl_add_u32 v3, v4, 2, v3
    v_lshlrev_b32 v5, 4, v3
    v_lshlrev_b32 v6, 4, v0
    s_mov_b32 s64, s48
    s_mov_b32 s65, s48
    s_mov_b32 s66, s48
    s_mov_b32 s67, 0
    s_mov_b32 s70, 0
    s_mov_b32 s71, s49
    v_mov_b32 v160, 0
    v_mov_b32 v138, 0
    v_mov_b32 v139, 0
    v_mul_u32_u24 v7, 448, v2
    v_lshl_add_u32 v7, v1, 4, v7
    s_lshl_b32 s51, s36, 6
    s_sub_u32 s51, 256, s51
    v_add_u32 v162, s51, v7
    v_subrev_u32 v163, 128, v162
    v_lshlrev_b32 v164, 12, v0
    v_add_u32 v164, 147456, v164
    s_lshl_b32 s51, s50, 12
    s_add_u32 s51, s51, 147456
    v_mov_b32 v167, s51
    v_mov_b32 v7, 0
    ds_write_b32 v167, v7
    s_lshl_b32 s51, s35, 2
    s_add_u32 s51, s51, s50
    v_lshlrev_b32 v7, 3, v2
    v_sub_u32 v7, v1, v7
    v_add_u32 v7, 18, v7
    v_mov_b32 v126, 0x5555
    v_mov_b32 v127, 0
    v_lshlrev_b64 v[126:127], v7, v[126:127]
    s_cmp_eq_u32 s51, 0
    s_cselect_b32 s52, 0, -1
    v_and_b32 v126, s52, v126
    v_not_b32 v126, v126
    v_not_b32 v127, v127
    s_mov_b32 s52, 0xf149f2ca
    v_mov_b32 v124, 0xdddddddd
    v_bfe_i32 v32, v127, 0, 1
    v_and_b32 v32, s52, v32
    v_mov_b32 v16, 0
    v_mov_b32 v48, 0
    v_bfe_i32 v33, v127, 1, 1
    v_and_b32 v33, s52, v33
    v_mov_b32 v17, 0
    v_mov_b32 v49, 0
    v_bfe_i32 v34, v127, 2, 1
    v_and_b32 v34, s52, v34
    v_mov_b32 v18, 0
    v_mov_b32 v50, 0
    v_bfe_i32 v35, v127, 3, 1
    v_and_b32 v35, s52, v35
    v_mov_b32 v19, 0
    v_mov_b32 v51, 0
    v_bfe_i32 v36, v127, 4, 1
    v_and_b32 v36, s52, v36
    v_mov_b32 v20, 0
    v_mov_b32 v52, 0
    v_bfe_i32 v37, v127, 5, 1
    v_and_b32 v37, s52, v37
    v_mov_b32 v21, 0
    v_mov_b32 v53, 0
    v_bfe_i32 v38, v127, 6, 1
    v_and_b32 v38, s52, v38
    v_mov_b32 v22, 0
    v_mov_b32 v54, 0
    v_bfe_i32 v39, v127, 7, 1
    v_and_b32 v39, s52, v39
    v_mov_b32 v23, 0
    v_mov_b32 v55, 0
    v_bfe_i32 v40, v127, 16, 1
    v_and_b32 v40, s52, v40
    v_bfe_i32 v24, v126, 16, 1
    v_and_b32 v24, s52, v24
    v_mov_b32 v56, 0
    v_bfe_i32 v41, v127, 17, 1
    v_and_b32 v41, s52, v41
    v_bfe_i32 v25, v126, 17, 1
    v_and_b32 v25, s52, v25
    v_mov_b32 v57, 0
    v_bfe_i32 v42, v127, 18, 1
    v_and_b32 v42, s52, v42
    v_bfe_i32 v26, v126, 18, 1
    v_and_b32 v26, s52, v26
    v_mov_b32 v58, 0
    v_bfe_i32 v43, v127, 19, 1
    v_and_b32 v43, s52, v43
    v_bfe_i32 v27, v126, 19, 1
    v_and_b32 v27, s52, v27
    v_mov_b32 v59, 0
    v_bfe_i32 v44, v127, 20, 1
    v_and_b32 v44, s52, v44
    v_bfe_i32 v28, v126, 20, 1
    v_and_b32 v28, s52, v28
    v_mov_b32 v60, 0
    v_bfe_i32 v45, v127, 21, 1
    v_and_b32 v45, s52, v45
    v_bfe_i32 v29, v126, 21, 1
    v_and_b32 v29, s52, v29
    v_mov_b32 v61, 0
    v_bfe_i32 v46, v127, 22, 1
    v_and_b32 v46, s52, v46
    v_bfe_i32 v30, v126, 22, 1
    v_and_b32 v30, s52, v30
    v_mov_b32 v62, 0
    v_bfe_i32 v47, v127, 23, 1
    v_and_b32 v47, s52, v47
    v_bfe_i32 v31, v126, 23, 1
    v_and_b32 v31, s52, v31
    v_mov_b32 v63, 0
    v_mov_b32 v112, 0x3f803f80
    v_mov_b32 v113, 0x3f803f80
    v_mov_b32 v114, 0x3f803f80
    v_mov_b32 v115, 0x3f803f80
    v_mov_b32 v116, 0x3f803f80
    v_mov_b32 v117, 0x3f803f80
    v_mov_b32 v118, 0x3f803f80
    v_mov_b32 v119, 0x3f803f80
    v_mov_b32 v120, 0x3f803f80
    v_mov_b32 v121, 0x3f803f80
    v_mov_b32 v122, 0x3f803f80
    v_mov_b32 v123, 0x3f803f80
    v_mov_b32 v140, 0x3e8b97f6
    v_mov_b32 v128, -1
    v_mov_b32 v129, -1
    v_mov_b32 v130, -1
    v_mov_b32 v131, -1
    v_and_b32 v7, 31, v3
    s_lshl_b32 s53, s36, 2
    v_subrev_u32 v7, s53, v7
    v_cmp_gt_u32 s[72:73], 28, v7
    v_mul_u32_u24 v125, 448, v2
    v_lshl_add_u32 v125, v7, 4, v125
    v_add_u32 v125, 256, v125
    s_mov_b64 s[76:77], s[56:57]
    s_mov_b32 s78, s58
    s_and_b32 s55, s50, 1
    s_lshl_b32 s52, s43, 1
    s_add_u32 s55, s55, s52
    s_lshr_b32 s51, s50, 1
    s_lshl_b32 s52, s55, 15
    s_lshl_b32 s53, s51, 14
    s_add_u32 s52, s52, s53
    s_add_u32 s52, s52, 11010048
    s_mul_i32 s55, s55, 57344
    s_lshl_b32 s53, s44, 7
    s_add_u32 s55, s55, s53
    s_lshl_b32 s53, s51, 6
    s_add_u32 s55, s55, s53
    s_add_u32 s55, s55, 0
    s_lshl_b32 s53, s50, 12
    s_xor_b32 s54, s53, 0x2000
    s_add_u32 s53, s53, 147456
    s_add_u32 s54, s54, 147456
    s_mul_i32 s57, s51, 28672
    s_add_u32 s57, s57, 57344
    s_lshl_b32 s58, s50, 2
    s_add_u32 s58, s58, 131072
    v_lshrrev_b32 v7, 5, v0
    v_bfe_u32 v4, v0, 2, 2
    v_lshl_add_u32 v144, v7, 3, v4
    v_lshlrev_b32 v144, 7, v144
    v_lshrrev_b32 v4, 1, v4
    v_xor_b32 v4, 0, v4
    v_lshl_add_u32 v144, v4, 6, v144
    v_bfe_u32 v4, v0, 4, 1
    v_lshl_add_u32 v144, v4, 5, v144
    v_and_b32 v4, 1, v0
    v_lshl_add_u32 v144, v4, 4, v144
    v_bfe_u32 v4, v0, 1, 1
    v_lshl_add_u32 v144, v4, 3, v144
    v_add_u32 v144, s57, v144
    v_xor_b32 v145, 64, v144
    v_add_u32 v146, s53, v6
    v_add_u32 v147, s54, v6
    v_mov_b32 v148, s58
    v_xor_b32 v149, 8, v148
    v_mov_b32 v150, 1
    v_mul_u32_u24 v151, 1792, v1
    v_lshl_add_u32 v151, v2, 4, v151
    v_add_u32 v152, 0x1000, v6
    v_add_u32 v153, 0x2000, v6
    v_add_u32 v154, 0x3000, v6
    s_mov_b64 s[56:57], s[76:77]
    s_mov_b32 s58, s78
    s_waitcnt lgkmcnt(0)
    s_mov_b32 s4, s68
    s_mov_b32 s5, s69
    s_mov_b32 s6, 401408
    s_mov_b32 s7, 0x20000
    s_mov_b32 s8, s74
    s_mov_b32 s9, s75
    s_mov_b32 s10, 401408
    s_mov_b32 s11, 0x20000
    s_lshl_b32 s58, s50, 12
    s_mul_i32 s59, s50, 28672
    s_add_u32 s59, s59, s37
    s_add_u32 s59, s59, 1835008
    s_lshl_b32 s60, s34, 6
    s_add_u32 s60, s60, s50
    s_mul_i32 s60, s60, 1792
    s_add_u32 s60, s60, 3669760
    buffer_load_dwordx2 v[158:159], v160, s[28:31], 0 offen sc1
    s_cmp_eq_u32 s50, 0
    s_cbranch_scc1 L_fu1
    buffer_load_dwordx2 v[158:159], v160, s[28:31], 0 offen sc1
    buffer_load_dwordx2 v[158:159], v160, s[28:31], 0 offen sc1
    buffer_load_dwordx2 v[158:159], v160, s[28:31], 0 offen sc1
    s_branch L_fud1
L_fu1:
    s_lshr_b32 s51, s37, 11
    s_add_u32 s52, s37, 1536
    s_lshr_b32 s52, s52, 11
    s_sub_u32 s52, s52, s51
    s_lshl_b32 s52, s52, 12
    v_mul_u32_u24 v7, s52, v2
    s_lshl_b32 s51, s51, 12
    s_add_u32 s79, s51, 15204352
    s_lshl_b32 s51, s35, 2
    s_add_u32 s52, s51, 3
    s_mul_i32 s51, s51, 86
    s_lshr_b32 s51, s51, 8
    s_mul_i32 s52, s52, 86
    s_lshr_b32 s52, s52, 8
    v_max_u32 v4, s51, v1
    v_min_u32 v4, s52, v4
    v_lshl_add_u32 v139, v4, 7, v7
    v_min_u32 v4, 21, v1
    v_lshl_add_u32 v138, v4, 7, v7
    v_add_u32 v138, 57344, v138
    s_add_u32 s80, s79, 57344
    buffer_load_dwordx2 v[132:133], v139, s[20:23], s79 offen sc1
    buffer_load_dwordx2 v[134:135], v138, s[20:23], s79 offen sc1
    buffer_load_dwordx2 v[136:137], v138, s[20:23], s80 offen sc1
L_fud1:
    s_barrier
    s_waitcnt vmcnt(0)
L_sv_att:
    s_cmp_eq_u32 s50, 0
    s_cbranch_scc0 L_relay
    s_mov_b32 s63, 0
non_1:
    v_readfirstlane_b32 s32, v158
    v_readfirstlane_b32 s33, v159
    s_add_u32 s63, s63, 1
    s_cmp_lg_u32 s33, 0
    s_cbranch_scc1 non_1_ok
    s_cmp_ge_u32 s63, 2000000
    s_cbranch_scc1 non_1_ok
    s_sleep 8
    buffer_load_dwordx2 v[158:159], v160, s[28:31], 0 offen sc1
    s_waitcnt vmcnt(0)
    s_branch non_1
non_1_ok:
    s_mov_b32 s63, 0
qf_2:
    v_cmp_ne_u64 vcc, s[32:33], v[132:133]
    v_cmp_ne_u64 s[52:53], s[32:33], v[134:135]
    v_cmp_ne_u64 s[54:55], s[32:33], v[136:137]
    s_add_u32 s63, s63, 1
    s_or_b64 s[56:57], s[52:53], vcc
    s_or_b64 s[56:57], s[56:57], s[54:55]
    s_cbranch_scc0 qf_2_ok
    s_cmp_ge_u32 s63, 2000000
    s_cbranch_scc1 qf_2_ok
    s_sleep 1
    s_or_b64 exec, vcc, 1
    buffer_load_dwordx2 v[132:133], v139, s[20:23], s79 offen sc1
    s_or_b64 exec, s[52:53], 1
    buffer_load_dwordx2 v[134:135], v138, s[20:23], s79 offen sc1
    s_or_b64 exec, s[54:55], 1
    buffer_load_dwordx2 v[136:137], v138, s[20:23], s80 offen sc1
    s_mov_b64 exec, -1
    s_waitcnt vmcnt(0)
    s_branch qf_2
qf_2_ok:
    v_mov_b32 v7, 1
    s_mov_b64 exec, 14
    ds_write_b32 v164, v7
    s_mov_b64 exec, -1
    s_branch L_relay_ok
L_relay:
    s_mov_b32 s63, 0
L_relay_w:
    ds_read_b32 v7, v167
    s_add_u32 s63, s63, 1
    s_waitcnt lgkmcnt(0)
    v_cmp_eq_u32 vcc, 0, v7
    s_cmp_ge_u32 s63, 32000000
    s_cbranch_scc1 L_relay_ok
    s_cbranch_vccnz L_relay_w
L_relay_ok:
    s_mul_i32 s56, s35, 114688
    s_add_u32 s56, s56, s59
    s_lshr_b32 s51, s58, 1
    s_add_u32 m0, s51, 57344
    s_sub_u32 s56, s56, 1835008
    buffer_load_dwordx4 v6, s[20:23], s56 offen sc1 lds
    buffer_load_dwordx4 v6, s[20:23], s56 offen offset:1024 sc1 lds
    s_add_u32 m0, s58, 98304
    s_add_u32 s56, s59, 0
    buffer_load_dwordx4 v6, s[20:23], s56 offen sc1 lds
    buffer_load_dwordx4 v6, s[20:23], s56 offen offset:1024 sc1 lds
    s_add_u32 m0, s58, 100352
    s_add_u32 s57, s60, 0
    s_mov_b64 exec, s[46:47]
    buffer_load_dwordx4 v162, s[20:23], s57 offen sc1 lds
    buffer_load_dwordx4 v163, s[20:23], s57 offen offset:1024 sc1 lds
    s_mov_b64 exec, -1
    s_add_u32 m0, s58, 114688
    s_add_u32 s56, s59, 114688
    buffer_load_dwordx4 v6, s[20:23], s56 offen sc1 lds
    buffer_load_dwordx4 v6, s[20:23], s56 offen offset:1024 sc1 lds
    s_add_u32 m0, s58, 116736
    s_add_u32 s57, s60, 7168
    s_mov_b64 exec, s[46:47]
    buffer_load_dwordx4 v162, s[20:23], s57 offen sc1 lds
    buffer_load_dwordx4 v163, s[20:23], s57 offen offset:1024 sc1 lds
    s_mov_b64 exec, -1
    s_add_u32 m0, s58, 131072
    s_add_u32 s56, s59, 229376
    buffer_load_dwordx4 v6, s[20:23], s56 offen sc1 lds
    buffer_load_dwordx4 v6, s[20:23], s56 offen offset:1024 sc1 lds
    s_add_u32 m0, s58, 133120
    s_add_u32 s57, s60, 14336
    s_mov_b64 exec, s[46:47]
    buffer_load_dwordx4 v162, s[20:23], s57 offen sc1 lds
    buffer_load_dwordx4 v163, s[20:23], s57 offen offset:1024 sc1 lds
    s_mov_b64 exec, -1
    s_mov_b32 s63, 0
non_3:
    v_readfirstlane_b32 s32, v158
    v_readfirstlane_b32 s33, v159
    s_add_u32 s63, s63, 1
    s_cmp_lg_u32 s33, 0
    s_cbranch_scc1 non_3_ok
    s_cmp_ge_u32 s63, 2000000
    s_cbranch_scc1 non_3_ok
    s_sleep 8
    buffer_load_dwordx2 v[158:159], v160, s[28:31], 0 offen sc1
    s_waitcnt vmcnt(0)
    s_branch non_3
non_3_ok:
    s_waitcnt vmcnt(8) lgkmcnt(0)
    s_barrier
    s_add_u32 m0, s58, 147456
    s_add_u32 s56, s59, 344064
    buffer_load_dwordx4 v6, s[20:23], s56 offen sc1 lds
    buffer_load_dwordx4 v6, s[20:23], s56 offen offset:1024 sc1 lds
    s_add_u32 m0, s58, 149504
    s_add_u32 s57, s60, 21504
    s_mov_b64 exec, s[46:47]
    buffer_load_dwordx4 v162, s[20:23], s57 offen sc1 lds
    buffer_load_dwordx4 v163, s[20:23], s57 offen offset:1024 sc1 lds
    s_mov_b64 exec, -1
    s_waitcnt vmcnt(4)
    s_barrier
    s_add_u32 m0, s58, 65536
    s_add_u32 s56, s59, 458752
    buffer_load_dwordx4 v6, s[20:23], s56 offen sc1 lds
    buffer_load_dwordx4 v6, s[20:23], s56 offen offset:1024 sc1 lds
    s_add_u32 m0, s58, 67584
    s_add_u32 s57, s60, 28672
    s_mov_b64 exec, s[46:47]
    buffer_load_dwordx4 v162, s[20:23], s57 offen sc1 lds
    buffer_load_dwordx4 v163, s[20:23], s57 offen offset:1024 sc1 lds
    s_mov_b64 exec, -1
    s_add_u32 m0, s58, 81920
    s_add_u32 s56, s59, 573440
    buffer_load_dwordx4 v6, s[20:23], s56 offen sc1 lds
    buffer_load_dwordx4 v6, s[20:23], s56 offen offset:1024 sc1 lds
    s_add_u32 m0, s58, 83968
    s_add_u32 s57, s60, 35840
    s_mov_b64 exec, s[46:47]
    buffer_load_dwordx4 v162, s[20:23], s57 offen sc1 lds
    buffer_load_dwordx4 v163, s[20:23], s57 offen offset:1024 sc1 lds
    s_mov_b64 exec, -1
    s_waitcnt vmcnt(4)
    s_barrier
    s_add_u32 m0, s58, 98304
    s_add_u32 s56, s59, 688128
    buffer_load_dwordx4 v6, s[20:23], s56 offen sc1 lds
    buffer_load_dwordx4 v6, s[20:23], s56 offen offset:1024 sc1 lds
    s_add_u32 m0, s58, 100352
    s_add_u32 s57, s60, 43008
    s_mov_b64 exec, s[46:47]
    buffer_load_dwordx4 v162, s[20:23], s57 offen sc1 lds
    buffer_load_dwordx4 v163, s[20:23], s57 offen offset:1024 sc1 lds
    s_mov_b64 exec, -1
    s_add_u32 m0, s58, 114688
    s_add_u32 s56, s59, 802816
    buffer_load_dwordx4 v6, s[20:23], s56 offen sc1 lds
    buffer_load_dwordx4 v6, s[20:23], s56 offen offset:1024 sc1 lds
    s_add_u32 m0, s58, 116736
    s_add_u32 s57, s60, 50176
    s_mov_b64 exec, s[46:47]
    buffer_load_dwordx4 v162, s[20:23], s57 offen sc1 lds
    buffer_load_dwordx4 v163, s[20:23], s57 offen offset:1024 sc1 lds
    s_mov_b64 exec, -1
    s_mul_i32 s61, s50, 7168
    s_lshl_b32 s62, s44, 7
    s_add_u32 s61, s61, s62
    s_lshl_b32 s62, s50, 10
    s_add_u32 m0, s62, 0
    s_add_u32 s63, s61, 0
    buffer_load_dwordx4 v161, s[8:11], s63 offen lds
    s_add_u32 m0, s62, 4096
    s_add_u32 s63, s61, 28672
    buffer_load_dwordx4 v161, s[8:11], s63 offen lds
    s_add_u32 m0, s62, 8192
    s_add_u32 s63, s61, 57344
    buffer_load_dwordx4 v161, s[8:11], s63 offen lds
    s_add_u32 m0, s62, 12288
    s_add_u32 s63, s61, 86016
    buffer_load_dwordx4 v161, s[8:11], s63 offen lds
    s_waitcnt vmcnt(8)
    s_barrier
    s_add_u32 m0, s58, 131072
    s_add_u32 s56, s59, 917504
    buffer_load_dwordx4 v6, s[20:23], s56 offen sc1 lds
    buffer_load_dwordx4 v6, s[20:23], s56 offen offset:1024 sc1 lds
    s_add_u32 m0, s58, 133120
    s_add_u32 s57, s60, 57344
    s_mov_b64 exec, s[46:47]
    buffer_load_dwordx4 v162, s[20:23], s57 offen sc1 lds
    buffer_load_dwordx4 v163, s[20:23], s57 offen offset:1024 sc1 lds
    s_mov_b64 exec, -1
    s_add_u32 m0, s58, 147456
    s_add_u32 s56, s59, 1032192
    buffer_load_dwordx4 v6, s[20:23], s56 offen sc1 lds
    buffer_load_dwordx4 v6, s[20:23], s56 offen offset:1024 sc1 lds
    s_add_u32 m0, s58, 149504
    s_add_u32 s57, s60, 64512
    s_mov_b64 exec, s[46:47]
    buffer_load_dwordx4 v162, s[20:23], s57 offen sc1 lds
    buffer_load_dwordx4 v163, s[20:23], s57 offen offset:1024 sc1 lds
    s_mov_b64 exec, -1
    s_mul_i32 s61, s50, 7168
    s_lshl_b32 s62, s44, 7
    s_add_u32 s61, s61, s62
    s_lshl_b32 s62, s50, 10
    s_add_u32 m0, s62, 16384
    s_add_u32 s63, s61, 114688
    buffer_load_dwordx4 v161, s[8:11], s63 offen lds
    s_add_u32 m0, s62, 20480
    s_add_u32 s63, s61, 143360
    buffer_load_dwordx4 v161, s[8:11], s63 offen lds
    s_add_u32 m0, s62, 24576
    s_add_u32 s63, s61, 172032
    buffer_load_dwordx4 v161, s[8:11], s63 offen lds
    s_add_u32 m0, s62, 28672
    s_add_u32 s63, s61, 200704
    buffer_load_dwordx4 v161, s[8:11], s63 offen lds
    s_add_u32 m0, s62, 32768
    s_add_u32 s63, s61, 229376
    buffer_load_dwordx4 v161, s[8:11], s63 offen lds
    s_add_u32 m0, s62, 36864
    s_add_u32 s63, s61, 258048
    buffer_load_dwordx4 v161, s[8:11], s63 offen lds
    s_lshl_b32 s51, s35, 2
    s_add_u32 s51, s51, s50
    s_lshl_b32 s51, s51, 4
    s_add_u32 s51, s51, s34
    s_lshl_b32 s51, s51, 11
    s_add_u32 s51, s51, 13107200
    buffer_store_dwordx4 v[128:131], v6, s[20:23], s51 offen sc1
    buffer_store_dwordx4 v[128:131], v6, s[20:23], s51 offen offset:1024 sc1
    s_lshr_b32 s51, s37, 11
    s_add_u32 s52, s37, 1536
    s_lshr_b32 s52, s52, 11
    s_sub_u32 s52, s52, s51
    s_lshl_b32 s52, s52, 12
    v_mul_u32_u24 v7, s52, v2
    s_lshl_b32 s51, s51, 12
    s_add_u32 s79, s51, 15376384
    s_lshl_b32 s51, s35, 2
    s_add_u32 s52, s51, s50
    s_max_u32 s51, s52, 1
    s_sub_u32 s51, s51, 1
    s_mul_i32 s51, s51, 86
    s_lshr_b32 s51, s51, 8
    s_mul_i32 s52, s52, 86
    s_lshr_b32 s52, s52, 8
    v_max_u32 v4, s51, v1
    v_min_u32 v4, s52, v4
    v_lshl_add_u32 v139, v4, 7, v7
    v_lshl_add_u32 v138, v4, 7, v7
    v_add_u32 v138, 57344, v138
    s_add_u32 s80, s79, 57344
    buffer_load_dwordx2 v[132:133], v139, s[20:23], s79 offen sc1
    buffer_load_dwordx2 v[134:135], v138, s[20:23], s79 offen sc1
    buffer_load_dwordx2 v[136:137], v138, s[20:23], s80 offen sc1
    s_waitcnt vmcnt(15)
    s_barrier
    s_add_u32 m0, s58, 65536
    s_add_u32 s56, s59, 1146880
    buffer_load_dwordx4 v6, s[20:23], s56 offen sc1 lds
    buffer_load_dwordx4 v6, s[20:23], s56 offen offset:1024 sc1 lds
    s_add_u32 m0, s58, 67584
    s_add_u32 s57, s60, 71680
    s_mov_b64 exec, s[46:47]
    buffer_load_dwordx4 v162, s[20:23], s57 offen sc1 lds
    buffer_load_dwordx4 v163, s[20:23], s57 offen offset:1024 sc1 lds
    s_mov_b64 exec, -1
    s_add_u32 m0, s58, 81920
    s_add_u32 s56, s59, 1261568
    buffer_load_dwordx4 v6, s[20:23], s56 offen sc1 lds
    buffer_load_dwordx4 v6, s[20:23], s56 offen offset:1024 sc1 lds
    s_add_u32 m0, s58, 83968
    s_add_u32 s57, s60, 78848
    s_mov_b64 exec, s[46:47]
    buffer_load_dwordx4 v162, s[20:23], s57 offen sc1 lds
    buffer_load_dwordx4 v163, s[20:23], s57 offen offset:1024 sc1 lds
    s_mov_b64 exec, -1
    s_waitcnt vmcnt(8)
    s_mov_b32 s63, 0
qf_4:
    v_cmp_ne_u64 vcc, s[32:33], v[132:133]
    v_cmp_ne_u64 s[52:53], s[32:33], v[134:135]
    v_cmp_ne_u64 s[54:55], s[32:33], v[136:137]
    s_add_u32 s63, s63, 1
    s_or_b64 s[56:57], s[52:53], vcc
    s_or_b64 s[56:57], s[56:57], s[54:55]
    s_cbranch_scc0 qf_4_ok
    s_cmp_ge_u32 s63, 2000000
    s_cbranch_scc1 qf_4_ok
    s_sleep 1
    s_or_b64 exec, vcc, 1
    buffer_load_dwordx2 v[132:133], v139, s[20:23], s79 offen sc1
    s_or_b64 exec, s[52:53], 1
    buffer_load_dwordx2 v[134:135], v138, s[20:23], s79 offen sc1
    s_or_b64 exec, s[54:55], 1
    buffer_load_dwordx2 v[136:137], v138, s[20:23], s80 offen sc1
    s_mov_b64 exec, -1
    s_waitcnt vmcnt(0)
    s_branch qf_4
qf_4_ok:
    s_lshl_b32 s51, s35, 2
    s_add_u32 s51, s51, s50
    s_mul_i32 s52, s51, 28672
    s_add_u32 s52, s52, s37
    s_add_u32 s53, s52, 7340032
    s_add_u32 s52, s52, 5505024
    s_cmp_eq_u32 s51, 0
    s_cselect_b32 s54, 0, 28672
    s_cselect_b32 s55, 0, 1792
    s_sub_u32 s54, s53, s54
    buffer_load_dwordx4 v[80:83], v6, s[20:23], s52 offen sc1
    buffer_load_dwordx4 v[84:87], v6, s[20:23], s52 offen offset:1024 sc1
    buffer_load_dwordx4 v[88:91], v5, s[20:23], s54 offen sc1
    buffer_load_dwordx4 v[92:95], v5, s[20:23], s54 offen offset:1024 sc1
    buffer_load_dwordx4 v[96:99], v5, s[20:23], s53 offen sc1
    buffer_load_dwordx4 v[100:103], v5, s[20:23], s53 offen offset:1024 sc1
    s_lshl_b32 s52, s34, 6
    s_add_u32 s52, s52, s51
    s_mul_i32 s52, s52, 1792
    s_add_u32 s52, s52, 9174784
    s_sub_u32 s55, s52, s55
    s_mov_b64 exec, s[72:73]
    buffer_load_dwordx4 v[112:115], v125, s[20:23], s55 offen offset:896 sc1
    buffer_load_dwordx4 v[116:119], v125, s[20:23], s52 offen sc1
    buffer_load_dwordx4 v[120:123], v125, s[20:23], s52 offen offset:896 sc1
    s_mov_b64 exec, -1
    s_waitcnt vmcnt(13)
    s_barrier
    s_add_u32 m0, s58, 98304
    s_add_u32 s56, s59, 1376256
    buffer_load_dwordx4 v6, s[20:23], s56 offen sc1 lds
    buffer_load_dwordx4 v6, s[20:23], s56 offen offset:1024 sc1 lds
    s_add_u32 m0, s58, 100352
    s_add_u32 s57, s60, 86016
    s_mov_b64 exec, s[46:47]
    buffer_load_dwordx4 v162, s[20:23], s57 offen sc1 lds
    buffer_load_dwordx4 v163, s[20:23], s57 offen offset:1024 sc1 lds
    s_mov_b64 exec, -1
    s_add_u32 m0, s58, 114688
    s_add_u32 s56, s59, 1490944
    buffer_load_dwordx4 v6, s[20:23], s56 offen sc1 lds
    buffer_load_dwordx4 v6, s[20:23], s56 offen offset:1024 sc1 lds
    s_add_u32 m0, s58, 116736
    s_add_u32 s57, s60, 93184
    s_mov_b64 exec, s[46:47]
    buffer_load_dwordx4 v162, s[20:23], s57 offen sc1 lds
    buffer_load_dwordx4 v163, s[20:23], s57 offen offset:1024 sc1 lds
    s_mov_b64 exec, -1
    s_mul_i32 s61, s50, 7168
    s_lshl_b32 s62, s44, 7
    s_add_u32 s61, s61, s62
    s_lshl_b32 s62, s50, 10
    s_add_u32 m0, s62, 40960
    s_add_u32 s63, s61, 286720
    buffer_load_dwordx4 v161, s[8:11], s63 offen lds
    s_add_u32 m0, s62, 45056
    s_add_u32 s63, s61, 315392
    buffer_load_dwordx4 v161, s[8:11], s63 offen lds
    s_add_u32 m0, s62, 49152
    s_add_u32 s63, s61, 344064
    buffer_load_dwordx4 v161, s[8:11], s63 offen lds
    s_add_u32 m0, s62, 53248
    s_add_u32 s63, s61, 372736
    buffer_load_dwordx4 v161, s[8:11], s63 offen lds
    s_waitcnt vmcnt(12)
    v_cndmask_b32 v80, v80, 0, s[66:67]
    v_cndmask_b32 v81, v81, 0, s[66:67]
    v_cndmask_b32 v86, v86, 0, s[70:71]
    v_cndmask_b32 v87, v87, 0, s[70:71]
    v_mfma_f32_32x32x16_bf16 v[16:31], v[88:91], v[80:83], v[16:31]
    v_mfma_f32_32x32x16_bf16 v[32:47], v[96:99], v[80:83], v[32:47]
    v_mfma_f32_32x32x16_bf16 v[16:31], v[92:95], v[84:87], v[16:31]
    v_mfma_f32_32x32x16_bf16 v[32:47], v[100:103], v[84:87], v[32:47]
    s_nop 11
    v_max_f32 v8, v24, v25
    v_max3_f32 v8, v8, v26, v27
    v_max3_f32 v8, v8, v28, v29
    v_max3_f32 v8, v8, v30, v31
    v_max3_f32 v8, v8, v32, v33
    v_max3_f32 v8, v8, v34, v35
    v_max3_f32 v8, v8, v36, v37
    v_max3_f32 v8, v8, v38, v39
    v_max3_f32 v8, v8, v40, v41
    v_max3_f32 v8, v8, v42, v43
    v_max3_f32 v8, v8, v44, v45
    v_max3_f32 v8, v8, v46, v47
    v_mov_b32 v9, v8
    s_nop 1
    v_permlane32_swap_b32 v8, v9
    v_max_f32 v8, v8, v9
    v_mul_f32 v8, v140, v8
    v_pk_fma_f32 v[24:25], v[24:25], v[140:141], v[8:9] op_sel_hi:[1,0,0] neg_lo:[0,0,1] neg_hi:[0,0,1]
    v_pk_fma_f32 v[26:27], v[26:27], v[140:141], v[8:9] op_sel_hi:[1,0,0] neg_lo:[0,0,1] neg_hi:[0,0,1]
    v_pk_fma_f32 v[28:29], v[28:29], v[140:141], v[8:9] op_sel_hi:[1,0,0] neg_lo:[0,0,1] neg_hi:[0,0,1]
    v_pk_fma_f32 v[30:31], v[30:31], v[140:141], v[8:9] op_sel_hi:[1,0,0] neg_lo:[0,0,1] neg_hi:[0,0,1]
    v_pk_fma_f32 v[32:33], v[32:33], v[140:141], v[8:9] op_sel_hi:[1,0,0] neg_lo:[0,0,1] neg_hi:[0,0,1]
    v_pk_fma_f32 v[34:35], v[34:35], v[140:141], v[8:9] op_sel_hi:[1,0,0] neg_lo:[0,0,1] neg_hi:[0,0,1]
    v_pk_fma_f32 v[36:37], v[36:37], v[140:141], v[8:9] op_sel_hi:[1,0,0] neg_lo:[0,0,1] neg_hi:[0,0,1]
    v_pk_fma_f32 v[38:39], v[38:39], v[140:141], v[8:9] op_sel_hi:[1,0,0] neg_lo:[0,0,1] neg_hi:[0,0,1]
    v_pk_fma_f32 v[40:41], v[40:41], v[140:141], v[8:9] op_sel_hi:[1,0,0] neg_lo:[0,0,1] neg_hi:[0,0,1]
    v_pk_fma_f32 v[42:43], v[42:43], v[140:141], v[8:9] op_sel_hi:[1,0,0] neg_lo:[0,0,1] neg_hi:[0,0,1]
    v_pk_fma_f32 v[44:45], v[44:45], v[140:141], v[8:9] op_sel_hi:[1,0,0] neg_lo:[0,0,1] neg_hi:[0,0,1]
    v_pk_fma_f32 v[46:47], v[46:47], v[140:141], v[8:9] op_sel_hi:[1,0,0] neg_lo:[0,0,1] neg_hi:[0,0,1]
    v_exp_f32 v24, v24
    v_exp_f32 v25, v25
    v_exp_f32 v26, v26
    v_exp_f32 v27, v27
    v_exp_f32 v28, v28
    v_exp_f32 v29, v29
    v_exp_f32 v30, v30
    v_exp_f32 v31, v31
    v_exp_f32 v32, v32
    v_exp_f32 v33, v33
    v_exp_f32 v34, v34
    v_exp_f32 v35, v35
    v_exp_f32 v36, v36
    v_exp_f32 v37, v37
    v_exp_f32 v38, v38
    v_exp_f32 v39, v39
    v_exp_f32 v40, v40
    v_exp_f32 v41, v41
    v_exp_f32 v42, v42
    v_exp_f32 v43, v43
    v_exp_f32 v44, v44
    v_exp_f32 v45, v45
    v_exp_f32 v46, v46
    v_exp_f32 v47, v47
    v_smfmac_f32_32x32x32_bf16 v[48:63], v[112:115], v[24:31], v124
    v_smfmac_f32_32x32x32_bf16 v[48:63], v[116:119], v[32:39], v124
    v_smfmac_f32_32x32x32_bf16 v[48:63], v[120:123], v[40:47], v124
    s_nop 7
    s_lshl_b32 s51, s35, 2
    s_add_u32 s51, s51, s50
    s_lshl_b32 s51, s51, 4
    s_add_u32 s51, s51, s34
    s_lshl_b32 s51, s51, 11
    s_add_u32 s51, s51, 11010048
    v_cndmask_b32 v64, v60, v48, s[64:65]
    v_cndmask_b32 v65, v60, v48, s[64:65]
    s_nop 1
    v_permlane32_swap_b32 v64, v65
    v_cndmask_b32 v64, v65, v64, s[64:65]
    v_rcp_f32 v66, v64
    s_nop 0
    v_cndmask_b32 v68, v66, 0, s[66:67]
    v_cndmask_b32 v70, v66, 0, s[70:71]
    v_pk_mul_f32 v[48:49], v[48:49], v[68:69] op_sel_hi:[1,0]
    v_pk_mul_f32 v[50:51], v[50:51], v[68:69] op_sel_hi:[1,0]
    v_pk_mul_f32 v[52:53], v[52:53], v[66:67] op_sel_hi:[1,0]
    v_pk_mul_f32 v[54:55], v[54:55], v[66:67] op_sel_hi:[1,0]
    v_cvt_pk_bf16_f32 v72, v48, v49
    v_min_u32 v72, -2, v72
    v_cvt_pk_bf16_f32 v73, v50, v51
    v_min_u32 v73, -2, v73
    v_cvt_pk_bf16_f32 v74, v52, v53
    v_min_u32 v74, -2, v74
    v_cvt_pk_bf16_f32 v75, v54, v55
    v_min_u32 v75, -2, v75
    buffer_store_dwordx4 v[72:75], v6, s[20:23], s51 offen offset:0 sc1
    v_pk_mul_f32 v[56:57], v[56:57], v[66:67] op_sel_hi:[1,0]
    v_pk_mul_f32 v[58:59], v[58:59], v[66:67] op_sel_hi:[1,0]
    v_pk_mul_f32 v[60:61], v[60:61], v[70:71] op_sel_hi:[1,0]
    v_pk_mul_f32 v[62:63], v[62:63], v[70:71] op_sel_hi:[1,0]
    v_cvt_pk_bf16_f32 v76, v56, v57
    v_min_u32 v76, -2, v76
    v_cvt_pk_bf16_f32 v77, v58, v59
    v_min_u32 v77, -2, v77
    v_cvt_pk_bf16_f32 v78, v60, v61
    v_min_u32 v78, -2, v78
    v_cvt_pk_bf16_f32 v79, v62, v63
    v_min_u32 v79, -2, v79
    buffer_store_dwordx4 v[76:79], v6, s[20:23], s51 offen offset:1024 sc1
    s_waitcnt vmcnt(10)
    s_barrier
    s_lshl_b32 s51, s35, 2
    s_add_u32 s51, s51, s50
    s_lshl_b32 s51, s51, 4
    s_add_u32 s51, s51, s34
    s_lshl_b32 s51, s51, 7
    s_add_u32 s51, s51, 15548416
    s_waitcnt vmcnt(0)
    s_mov_b64 exec, 1
    buffer_store_dwordx2 v[158:159], v160, s[20:23], s51 offen sc1
    s_mov_b64 exec, -1
    s_add_u32 m0, s58, 131072
    s_add_u32 s56, s59, 1605632
    buffer_load_dwordx4 v6, s[20:23], s56 offen sc1 lds
    buffer_load_dwordx4 v6, s[20:23], s56 offen offset:1024 sc1 lds
    s_add_u32 m0, s58, 133120
    s_add_u32 s57, s60, 100352
    s_mov_b64 exec, s[46:47]
    buffer_load_dwordx4 v162, s[20:23], s57 offen sc1 lds
    buffer_load_dwordx4 v163, s[20:23], s57 offen offset:1024 sc1 lds
    s_mov_b64 exec, -1
    s_add_u32 m0, s58, 147456
    s_add_u32 s56, s59, 1720320
    buffer_load_dwordx4 v6, s[20:23], s56 offen sc1 lds
    buffer_load_dwordx4 v6, s[20:23], s56 offen offset:1024 sc1 lds
    s_add_u32 m0, s58, 149504
    s_add_u32 s57, s60, 107520
    s_mov_b64 exec, s[46:47]
    buffer_load_dwordx4 v162, s[20:23], s57 offen sc1 lds
    buffer_load_dwordx4 v163, s[20:23], s57 offen offset:1024 sc1 lds
    s_mov_b64 exec, -1
    s_mul_i32 s61, s50, 7168
    s_lshl_b32 s62, s44, 7
    s_add_u32 s61, s61, s62
    s_lshl_b32 s62, s50, 10
    s_add_u32 m0, s62, 57344
    s_add_u32 s63, s61, 0
    buffer_load_dwordx4 v161, s[4:7], s63 offen lds
    s_add_u32 m0, s62, 61440
    s_add_u32 s63, s61, 28672
    buffer_load_dwordx4 v161, s[4:7], s63 offen lds
    s_waitcnt vmcnt(6)
    s_barrier
    s_mul_i32 s61, s50, 7168
    s_lshl_b32 s62, s44, 7
    s_add_u32 s61, s61, s62
    s_lshl_b32 s62, s50, 10
    s_add_u32 m0, s62, 65536
    s_add_u32 s63, s61, 57344
    buffer_load_dwordx4 v161, s[4:7], s63 offen lds
    s_add_u32 m0, s62, 69632
    s_add_u32 s63, s61, 86016
    buffer_load_dwordx4 v161, s[4:7], s63 offen lds
    s_add_u32 m0, s62, 73728
    s_add_u32 s63, s61, 114688
    buffer_load_dwordx4 v161, s[4:7], s63 offen lds
    s_add_u32 m0, s62, 77824
    s_add_u32 s63, s61, 143360
    buffer_load_dwordx4 v161, s[4:7], s63 offen lds
    s_add_u32 m0, s62, 81920
    s_add_u32 s63, s61, 172032
    buffer_load_dwordx4 v161, s[4:7], s63 offen lds
    s_add_u32 m0, s62, 86016
    s_add_u32 s63, s61, 200704
    buffer_load_dwordx4 v161, s[4:7], s63 offen lds
    s_add_u32 m0, s62, 90112
    s_add_u32 s63, s61, 229376
    buffer_load_dwordx4 v161, s[4:7], s63 offen lds
    s_add_u32 m0, s62, 94208
    s_add_u32 s63, s61, 258048
    buffer_load_dwordx4 v161, s[4:7], s63 offen lds
    s_and_b32 s55, s50, 1
    s_lshl_b32 s52, s43, 1
    s_add_u32 s55, s55, s52
    s_lshr_b32 s51, s50, 1
    s_lshl_b32 s52, s55, 15
    s_lshl_b32 s53, s51, 14
    s_add_u32 s52, s52, s53
    s_add_u32 s52, s52, 11010048
    s_mul_i32 s55, s55, 57344
    s_lshl_b32 s53, s44, 7
    s_add_u32 s55, s55, s53
    s_lshl_b32 s53, s51, 6
    s_add_u32 s55, s55, s53
    s_add_u32 s55, s55, 0
    s_lshl_b32 s53, s50, 12
    s_xor_b32 s54, s53, 0x2000
    s_add_u32 s53, s53, 147456
    s_add_u32 s54, s54, 147456
    s_mul_i32 s57, s51, 28672
    s_add_u32 s57, s57, 57344
    s_lshl_b32 s58, s50, 2
    s_add_u32 s58, s58, 131072
    s_waitcnt vmcnt(0)
    s_sub_u32 s59, s52, 11010048
    s_lshr_b32 s59, s59, 4
    s_add_u32 s59, s59, 15548416
    v_min_u32 v10, 7, v0
    v_lshlrev_b32 v10, 7, v10
    buffer_load_dwordx2 v[8:9], v10, s[20:23], s59 offen sc1
    s_barrier
    s_mul_i32 s61, s50, 7168
    s_lshl_b32 s62, s44, 7
    s_add_u32 s61, s61, s62
    s_lshl_b32 s62, s50, 10
    s_add_u32 m0, s62, 98304
    s_add_u32 s63, s61, 286720
    buffer_load_dwordx4 v161, s[4:7], s63 offen lds
    s_add_u32 m0, s62, 102400
    s_add_u32 s63, s61, 315392
    buffer_load_dwordx4 v161, s[4:7], s63 offen lds
    s_add_u32 m0, s62, 106496
    s_add_u32 s63, s61, 344064
    buffer_load_dwordx4 v161, s[4:7], s63 offen lds
    s_add_u32 m0, s62, 110592
    s_add_u32 s63, s61, 372736
    buffer_load_dwordx4 v161, s[4:7], s63 offen lds
    s_waitcnt vmcnt(4)
    s_mov_b32 s63, 0
L_of:
    v_cmp_ne_u64 vcc, s[32:33], v[8:9]
    s_add_u32 s63, s63, 1
    s_cbranch_vccz L_of_ok
    s_cmp_ge_u32 s63, 2000000
    s_cbranch_scc1 L_of_ok
    s_sleep 2
    s_mov_b64 exec, vcc
    buffer_load_dwordx2 v[8:9], v10, s[20:23], s59 offen sc1
    s_mov_b64 exec, -1
    s_waitcnt vmcnt(0)
    s_branch L_of
L_of_ok:
    buffer_load_dwordx4 v[16:19], v6, s[20:23], s52 offen offset:0 sc1
    buffer_load_dwordx4 v[20:23], v6, s[20:23], s52 offen offset:1024 sc1
    buffer_load_dwordx4 v[24:27], v6, s[20:23], s52 offen offset:2048 sc1
    buffer_load_dwordx4 v[28:31], v6, s[20:23], s52 offen offset:3072 sc1
    buffer_load_dwordx4 v[32:35], v152, s[20:23], s52 offen offset:0 sc1
    buffer_load_dwordx4 v[36:39], v152, s[20:23], s52 offen offset:1024 sc1
    buffer_load_dwordx4 v[40:43], v152, s[20:23], s52 offen offset:2048 sc1
    buffer_load_dwordx4 v[44:47], v152, s[20:23], s52 offen offset:3072 sc1
    buffer_load_dwordx4 v[48:51], v153, s[20:23], s52 offen offset:0 sc1
    buffer_load_dwordx4 v[52:55], v153, s[20:23], s52 offen offset:1024 sc1
    buffer_load_dwordx4 v[56:59], v153, s[20:23], s52 offen offset:2048 sc1
    buffer_load_dwordx4 v[60:63], v153, s[20:23], s52 offen offset:3072 sc1
    buffer_load_dwordx4 v[64:67], v154, s[20:23], s52 offen offset:0 sc1
    buffer_load_dwordx4 v[68:71], v154, s[20:23], s52 offen offset:1024 sc1
    buffer_load_dwordx4 v[72:75], v154, s[20:23], s52 offen offset:2048 sc1
    buffer_load_dwordx4 v[76:79], v154, s[20:23], s52 offen offset:3072 sc1
    s_waitcnt vmcnt(16)
    v_mov_b32 v7, 131072
    v_lshl_add_u32 v7, v0, 2, v7
    v_mov_b32 v4, 0
    s_mov_b64 exec, 0xff
    ds_write_b32 v7, v4
    s_mov_b64 exec, -1
    s_waitcnt lgkmcnt(0)
    s_barrier
    s_barrier
    s_setprio 0
    s_cmp_eq_u32 s45, 0
    s_cbranch_scc1 L_end
L_oproj:
    ds_read_b64_tr_b16 v[112:113], v144 offset:0
    ds_read_b64_tr_b16 v[114:115], v144 offset:512
    ds_read_b64_tr_b16 v[116:117], v145 offset:0
    ds_read_b64_tr_b16 v[118:119], v145 offset:512
    ds_read_b64_tr_b16 v[120:121], v144 offset:2048
    ds_read_b64_tr_b16 v[122:123], v144 offset:2560
    ds_read_b64_tr_b16 v[124:125], v145 offset:2048
    ds_read_b64_tr_b16 v[126:127], v145 offset:2560
    ds_read_b64_tr_b16 v[128:129], v144 offset:3072
    ds_read_b64_tr_b16 v[130:131], v144 offset:3584
    ds_read_b64_tr_b16 v[132:133], v145 offset:3072
    ds_read_b64_tr_b16 v[134:135], v145 offset:3584
    s_mov_b32 s63, 0
    s_movk_i32 s56, 0
    s_waitcnt vmcnt(14)
    v_max3_u32 v7, v16, v17, v18
    v_max3_u32 v4, v19, v20, v21
    v_max3_u32 v7, v7, v22, v23
    v_max_u32 v7, v7, v4
    v_cmp_eq_u32 vcc, -1, v7
    s_waitcnt lgkmcnt(8)
    s_cbranch_vccnz L_oretry
L_ob0:
    v_mfma_f32_32x32x16_bf16 v[80:95], v[112:115], v[16:19], 0
    ds_read_b64_tr_b16 v[136:137], v144 offset:5120
    ds_read_b64_tr_b16 v[138:139], v144 offset:5632
    v_mfma_f32_32x32x16_bf16 v[96:111], v[116:119], v[16:19], 0
    ds_read_b64_tr_b16 v[140:141], v145 offset:5120
    ds_read_b64_tr_b16 v[142:143], v145 offset:5632
    s_waitcnt lgkmcnt(8)
    v_mfma_f32_32x32x16_bf16 v[80:95], v[120:123], v[20:23], v[80:95]
    ds_read_b64_tr_b16 v[112:113], v144 offset:7168
    ds_read_b64_tr_b16 v[114:115], v144 offset:7680
    ds_read_b64_tr_b16 v[116:117], v145 offset:7168
    ds_read_b64_tr_b16 v[118:119], v145 offset:7680
    s_waitcnt vmcnt(12)
    v_mfma_f32_32x32x16_bf16 v[96:111], v[124:127], v[20:23], v[96:111]
    v_max3_u32 v7, v24, v25, v26
    v_max3_u32 v4, v27, v28, v29
    v_max3_u32 v7, v7, v30, v31
    v_max_u32 v7, v7, v4
    v_cmp_eq_u32 vcc, -1, v7
    s_movk_i32 s56, 1
    s_waitcnt lgkmcnt(8)
    s_cbranch_vccnz L_oretry
L_ob1:
    v_mfma_f32_32x32x16_bf16 v[80:95], v[128:131], v[24:27], v[80:95]
    ds_read_b64_tr_b16 v[120:121], v144 offset:9216
    ds_read_b64_tr_b16 v[122:123], v144 offset:9728
    v_mfma_f32_32x32x16_bf16 v[96:111], v[132:135], v[24:27], v[96:111]
    ds_read_b64_tr_b16 v[124:125], v145 offset:9216
    ds_read_b64_tr_b16 v[126:127], v145 offset:9728
    s_waitcnt lgkmcnt(8)
    v_mfma_f32_32x32x16_bf16 v[80:95], v[136:139], v[28:31], v[80:95]
    ds_read_b64_tr_b16 v[128:129], v144 offset:10240
    ds_read_b64_tr_b16 v[130:131], v144 offset:10752
    ds_read_b64_tr_b16 v[132:133], v145 offset:10240
    ds_read_b64_tr_b16 v[134:135], v145 offset:10752
    s_waitcnt vmcnt(10)
    v_mfma_f32_32x32x16_bf16 v[96:111], v[140:143], v[28:31], v[96:111]
    v_max3_u32 v7, v32, v33, v34
    v_max3_u32 v4, v35, v36, v37
    v_max3_u32 v7, v7, v38, v39
    v_max_u32 v7, v7, v4
    v_cmp_eq_u32 vcc, -1, v7
    s_movk_i32 s56, 2
    s_waitcnt lgkmcnt(8)
    s_cbranch_vccnz L_oretry
L_ob2:
    v_mfma_f32_32x32x16_bf16 v[80:95], v[112:115], v[32:35], v[80:95]
    ds_read_b64_tr_b16 v[136:137], v144 offset:12288
    ds_read_b64_tr_b16 v[138:139], v144 offset:12800
    v_mfma_f32_32x32x16_bf16 v[96:111], v[116:119], v[32:35], v[96:111]
    ds_read_b64_tr_b16 v[140:141], v145 offset:12288
    ds_read_b64_tr_b16 v[142:143], v145 offset:12800
    s_waitcnt lgkmcnt(8)
    v_mfma_f32_32x32x16_bf16 v[80:95], v[120:123], v[36:39], v[80:95]
    ds_read_b64_tr_b16 v[112:113], v144 offset:14336
    ds_read_b64_tr_b16 v[114:115], v144 offset:14848
    ds_read_b64_tr_b16 v[116:117], v145 offset:14336
    ds_read_b64_tr_b16 v[118:119], v145 offset:14848
    s_waitcnt vmcnt(8)
    v_mfma_f32_32x32x16_bf16 v[96:111], v[124:127], v[36:39], v[96:111]
    v_max3_u32 v7, v40, v41, v42
    v_max3_u32 v4, v43, v44, v45
    v_max3_u32 v7, v7, v46, v47
    v_max_u32 v7, v7, v4
    v_cmp_eq_u32 vcc, -1, v7
    s_movk_i32 s56, 3
    s_waitcnt lgkmcnt(8)
    s_cbranch_vccnz L_oretry
L_ob3:
    v_mfma_f32_32x32x16_bf16 v[80:95], v[128:131], v[40:43], v[80:95]
    ds_read_b64_tr_b16 v[120:121], v144 offset:16384
    ds_read_b64_tr_b16 v[122:123], v144 offset:16896
    v_mfma_f32_32x32x16_bf16 v[96:111], v[132:135], v[40:43], v[96:111]
    ds_read_b64_tr_b16 v[124:125], v145 offset:16384
    ds_read_b64_tr_b16 v[126:127], v145 offset:16896
    s_waitcnt lgkmcnt(8)
    v_mfma_f32_32x32x16_bf16 v[80:95], v[136:139], v[44:47], v[80:95]
    ds_read_b64_tr_b16 v[128:129], v144 offset:17408
    ds_read_b64_tr_b16 v[130:131], v144 offset:17920
    ds_read_b64_tr_b16 v[132:133], v145 offset:17408
    ds_read_b64_tr_b16 v[134:135], v145 offset:17920
    s_waitcnt vmcnt(6)
    v_mfma_f32_32x32x16_bf16 v[96:111], v[140:143], v[44:47], v[96:111]
    v_max3_u32 v7, v48, v49, v50
    v_max3_u32 v4, v51, v52, v53
    v_max3_u32 v7, v7, v54, v55
    v_max_u32 v7, v7, v4
    v_cmp_eq_u32 vcc, -1, v7
    s_movk_i32 s56, 4
    s_waitcnt lgkmcnt(8)
    s_cbranch_vccnz L_oretry
L_ob4:
    v_mfma_f32_32x32x16_bf16 v[80:95], v[112:115], v[48:51], v[80:95]
    ds_read_b64_tr_b16 v[136:137], v144 offset:19456
    ds_read_b64_tr_b16 v[138:139], v144 offset:19968
    v_mfma_f32_32x32x16_bf16 v[96:111], v[116:119], v[48:51], v[96:111]
    ds_read_b64_tr_b16 v[140:141], v145 offset:19456
    ds_read_b64_tr_b16 v[142:143], v145 offset:19968
    s_waitcnt lgkmcnt(8)
    v_mfma_f32_32x32x16_bf16 v[80:95], v[120:123], v[52:55], v[80:95]
    ds_read_b64_tr_b16 v[112:113], v144 offset:21504
    ds_read_b64_tr_b16 v[114:115], v144 offset:22016
    ds_read_b64_tr_b16 v[116:117], v145 offset:21504
    ds_read_b64_tr_b16 v[118:119], v145 offset:22016
    s_waitcnt vmcnt(4)
    v_mfma_f32_32x32x16_bf16 v[96:111], v[124:127], v[52:55], v[96:111]
    v_max3_u32 v7, v56, v57, v58
    v_max3_u32 v4, v59, v60, v61
    v_max3_u32 v7, v7, v62, v63
    v_max_u32 v7, v7, v4
    v_cmp_eq_u32 vcc, -1, v7
    s_movk_i32 s56, 5
    s_waitcnt lgkmcnt(8)
    s_cbranch_vccnz L_oretry
L_ob5:
    v_mfma_f32_32x32x16_bf16 v[80:95], v[128:131], v[56:59], v[80:95]
    ds_read_b64_tr_b16 v[120:121], v144 offset:23552
    ds_read_b64_tr_b16 v[122:123], v144 offset:24064
    v_mfma_f32_32x32x16_bf16 v[96:111], v[132:135], v[56:59], v[96:111]
    ds_read_b64_tr_b16 v[124:125], v145 offset:23552
    ds_read_b64_tr_b16 v[126:127], v145 offset:24064
    s_waitcnt lgkmcnt(8)
    v_mfma_f32_32x32x16_bf16 v[80:95], v[136:139], v[60:63], v[80:95]
    ds_read_b64_tr_b16 v[128:129], v144 offset:24576
    ds_read_b64_tr_b16 v[130:131], v144 offset:25088
    ds_read_b64_tr_b16 v[132:133], v145 offset:24576
    ds_read_b64_tr_b16 v[134:135], v145 offset:25088
    s_waitcnt vmcnt(2)
    v_mfma_f32_32x32x16_bf16 v[96:111], v[140:143], v[60:63], v[96:111]
    v_max3_u32 v7, v64, v65, v66
    v_max3_u32 v4, v67, v68, v69
    v_max3_u32 v7, v7, v70, v71
    v_max_u32 v7, v7, v4
    v_cmp_eq_u32 vcc, -1, v7
    s_movk_i32 s56, 6
    s_waitcnt lgkmcnt(8)
    s_cbranch_vccnz L_oretry
L_ob6:
    v_mfma_f32_32x32x16_bf16 v[80:95], v[112:115], v[64:67], v[80:95]
    ds_read_b64_tr_b16 v[136:137], v144 offset:26624
    ds_read_b64_tr_b16 v[138:139], v144 offset:27136
    v_mfma_f32_32x32x16_bf16 v[96:111], v[116:119], v[64:67], v[96:111]
    ds_read_b64_tr_b16 v[140:141], v145 offset:26624
    ds_read_b64_tr_b16 v[142:143], v145 offset:27136
    s_waitcnt lgkmcnt(8)
    v_mfma_f32_32x32x16_bf16 v[80:95], v[120:123], v[68:71], v[80:95]
    s_waitcnt vmcnt(0)
    v_mfma_f32_32x32x16_bf16 v[96:111], v[124:127], v[68:71], v[96:111]
    v_max3_u32 v7, v72, v73, v74
    v_max3_u32 v4, v75, v76, v77
    v_max3_u32 v7, v7, v78, v79
    v_max_u32 v7, v7, v4
    v_cmp_eq_u32 vcc, -1, v7
    s_movk_i32 s56, 7
    s_waitcnt lgkmcnt(4)
    s_cbranch_vccnz L_oretry
L_ob7:
    v_mfma_f32_32x32x16_bf16 v[80:95], v[128:131], v[72:75], v[80:95]
    v_mfma_f32_32x32x16_bf16 v[96:111], v[132:135], v[72:75], v[96:111]
    s_waitcnt lgkmcnt(0)
    v_mfma_f32_32x32x16_bf16 v[80:95], v[136:139], v[76:79], v[80:95]
    v_mfma_f32_32x32x16_bf16 v[96:111], v[140:143], v[76:79], v[96:111]
    s_branch L_odone
L_oretry:
    s_mov_b32 s60, 0
    s_brev_b32 s61, 1
    s_waitcnt vmcnt(0)
L_ore2:
    s_mov_b32 s59, 0
    s_cmp_gt_u32 s56, 0
    s_cbranch_scc1 L_o2_0
    v_max3_u32 v7, v16, v17, v18
    v_max3_u32 v4, v19, v20, v21
    v_max3_u32 v7, v7, v22, v23
    v_max_u32 v7, v7, v4
    v_cmp_eq_u32 vcc, -1, v7
    s_nop 0
    s_cbranch_vccz L_o2_0
    s_bitset1_b32 s59, 0
    buffer_load_dwordx4 v[16:19], v6, s[20:23], s52 offen offset:0 sc1
    buffer_load_dwordx4 v[20:23], v6, s[20:23], s52 offen offset:1024 sc1
L_o2_0:
    s_cmp_gt_u32 s56, 1
    s_cbranch_scc1 L_o2_1
    v_max3_u32 v7, v24, v25, v26
    v_max3_u32 v4, v27, v28, v29
    v_max3_u32 v7, v7, v30, v31
    v_max_u32 v7, v7, v4
    v_cmp_eq_u32 vcc, -1, v7
    s_nop 0
    s_cbranch_vccz L_o2_1
    s_bitset1_b32 s59, 1
    buffer_load_dwordx4 v[24:27], v6, s[20:23], s52 offen offset:2048 sc1
    buffer_load_dwordx4 v[28:31], v6, s[20:23], s52 offen offset:3072 sc1
L_o2_1:
    s_cmp_gt_u32 s56, 2
    s_cbranch_scc1 L_o2_2
    v_max3_u32 v7, v32, v33, v34
    v_max3_u32 v4, v35, v36, v37
    v_max3_u32 v7, v7, v38, v39
    v_max_u32 v7, v7, v4
    v_cmp_eq_u32 vcc, -1, v7
    s_nop 0
    s_cbranch_vccz L_o2_2
    s_bitset1_b32 s59, 2
    buffer_load_dwordx4 v[32:35], v152, s[20:23], s52 offen offset:0 sc1
    buffer_load_dwordx4 v[36:39], v152, s[20:23], s52 offen offset:1024 sc1
L_o2_2:
    s_cmp_gt_u32 s56, 3
    s_cbranch_scc1 L_o2_3
    v_max3_u32 v7, v40, v41, v42
    v_max3_u32 v4, v43, v44, v45
    v_max3_u32 v7, v7, v46, v47
    v_max_u32 v7, v7, v4
    v_cmp_eq_u32 vcc, -1, v7
    s_nop 0
    s_cbranch_vccz L_o2_3
    s_bitset1_b32 s59, 3
    buffer_load_dwordx4 v[40:43], v152, s[20:23], s52 offen offset:2048 sc1
    buffer_load_dwordx4 v[44:47], v152, s[20:23], s52 offen offset:3072 sc1
L_o2_3:
    s_cmp_gt_u32 s56, 4
    s_cbranch_scc1 L_o2_4
    v_max3_u32 v7, v48, v49, v50
    v_max3_u32 v4, v51, v52, v53
    v_max3_u32 v7, v7, v54, v55
    v_max_u32 v7, v7, v4
    v_cmp_eq_u32 vcc, -1, v7
    s_nop 0
    s_cbranch_vccz L_o2_4
    s_bitset1_b32 s59, 4
    buffer_load_dwordx4 v[48:51], v153, s[20:23], s52 offen offset:0 sc1
    buffer_load_dwordx4 v[52:55], v153, s[20:23], s52 offen offset:1024 sc1
L_o2_4:
    s_cmp_gt_u32 s56, 5
    s_cbranch_scc1 L_o2_5
    v_max3_u32 v7, v56, v57, v58
    v_max3_u32 v4, v59, v60, v61
    v_max3_u32 v7, v7, v62, v63
    v_max_u32 v7, v7, v4
    v_cmp_eq_u32 vcc, -1, v7
    s_nop 0
    s_cbranch_vccz L_o2_5
    s_bitset1_b32 s59, 5
    buffer_load_dwordx4 v[56:59], v153, s[20:23], s52 offen offset:2048 sc1
    buffer_load_dwordx4 v[60:63], v153, s[20:23], s52 offen offset:3072 sc1
L_o2_5:
    s_cmp_gt_u32 s56, 6
    s_cbranch_scc1 L_o2_6
    v_max3_u32 v7, v64, v65, v66
    v_max3_u32 v4, v67, v68, v69
    v_max3_u32 v7, v7, v70, v71
    v_max_u32 v7, v7, v4
    v_cmp_eq_u32 vcc, -1, v7
    s_nop 0
    s_cbranch_vccz L_o2_6
    s_bitset1_b32 s59, 6
    buffer_load_dwordx4 v[64:67], v154, s[20:23], s52 offen offset:0 sc1
    buffer_load_dwordx4 v[68:71], v154, s[20:23], s52 offen offset:1024 sc1
L_o2_6:
    s_cmp_gt_u32 s56, 7
    s_cbranch_scc1 L_o2_7
    v_max3_u32 v7, v72, v73, v74
    v_max3_u32 v4, v75, v76, v77
    v_max3_u32 v7, v7, v78, v79
    v_max_u32 v7, v7, v4
    v_cmp_eq_u32 vcc, -1, v7
    s_nop 0
    s_cbranch_vccz L_o2_7
    s_bitset1_b32 s59, 7
    buffer_load_dwordx4 v[72:75], v154, s[20:23], s52 offen offset:2048 sc1
    buffer_load_dwordx4 v[76:79], v154, s[20:23], s52 offen offset:3072 sc1
L_o2_7:
    s_add_u32 s63, s63, 1
    s_waitcnt vmcnt(0)
    s_cmp_ge_u32 s63, 2000000
    s_cbranch_scc1 L_oret
    s_bitcmp1_b32 s59, s56
    s_cbranch_scc0 L_oret
    s_cmp_eq_u32 s56, 0
    s_cbranch_scc0 L_o4_0
    v_max3_u32 v7, v16, v17, v18
    v_max3_u32 v4, v19, v20, v21
    v_max3_u32 v7, v7, v22, v23
    v_max_u32 v7, v7, v4
    v_cmp_eq_u32 vcc, -1, v7
    s_nop 0
    s_cbranch_vccz L_ob0
    s_branch L_osl
L_o4_0:
    s_cmp_eq_u32 s56, 1
    s_cbranch_scc0 L_o4_1
    v_max3_u32 v7, v24, v25, v26
    v_max3_u32 v4, v27, v28, v29
    v_max3_u32 v7, v7, v30, v31
    v_max_u32 v7, v7, v4
    v_cmp_eq_u32 vcc, -1, v7
    s_nop 0
    s_cbranch_vccz L_ob1
    s_branch L_osl
L_o4_1:
    s_cmp_eq_u32 s56, 2
    s_cbranch_scc0 L_o4_2
    v_max3_u32 v7, v32, v33, v34
    v_max3_u32 v4, v35, v36, v37
    v_max3_u32 v7, v7, v38, v39
    v_max_u32 v7, v7, v4
    v_cmp_eq_u32 vcc, -1, v7
    s_nop 0
    s_cbranch_vccz L_ob2
    s_branch L_osl
L_o4_2:
    s_cmp_eq_u32 s56, 3
    s_cbranch_scc0 L_o4_3
    v_max3_u32 v7, v40, v41, v42
    v_max3_u32 v4, v43, v44, v45
    v_max3_u32 v7, v7, v46, v47
    v_max_u32 v7, v7, v4
    v_cmp_eq_u32 vcc, -1, v7
    s_nop 0
    s_cbranch_vccz L_ob3
    s_branch L_osl
L_o4_3:
    s_cmp_eq_u32 s56, 4
    s_cbranch_scc0 L_o4_4
    v_max3_u32 v7, v48, v49, v50
    v_max3_u32 v4, v51, v52, v53
    v_max3_u32 v7, v7, v54, v55
    v_max_u32 v7, v7, v4
    v_cmp_eq_u32 vcc, -1, v7
    s_nop 0
    s_cbranch_vccz L_ob4
    s_branch L_osl
L_o4_4:
    s_cmp_eq_u32 s56, 5
    s_cbranch_scc0 L_o4_5
    v_max3_u32 v7, v56, v57, v58
    v_max3_u32 v4, v59, v60, v61
    v_max3_u32 v7, v7, v62, v63
    v_max_u32 v7, v7, v4
    v_cmp_eq_u32 vcc, -1, v7
    s_nop 0
    s_cbranch_vccz L_ob5
    s_branch L_osl
L_o4_5:
    s_cmp_eq_u32 s56, 6
    s_cbranch_scc0 L_o4_6
    v_max3_u32 v7, v64, v65, v66
    v_max3_u32 v4, v67, v68, v69
    v_max3_u32 v7, v7, v70, v71
    v_max_u32 v7, v7, v4
    v_cmp_eq_u32 vcc, -1, v7
    s_nop 0
    s_cbranch_vccz L_ob6
    s_branch L_osl
L_o4_6:
    s_cmp_eq_u32 s56, 7
    s_cbranch_scc0 L_o4_7
    v_max3_u32 v7, v72, v73, v74
    v_max3_u32 v4, v75, v76, v77
    v_max3_u32 v7, v7, v78, v79
    v_max_u32 v7, v7, v4
    v_cmp_eq_u32 vcc, -1, v7
    s_nop 0
    s_cbranch_vccz L_ob7
    s_branch L_osl
L_o4_7:
L_osl:
    s_sleep 1
    s_branch L_ore2
L_oret:
    s_cmp_eq_u32 s56, 0
    s_cbranch_scc1 L_ob0
    s_cmp_eq_u32 s56, 1
    s_cbranch_scc1 L_ob1
    s_cmp_eq_u32 s56, 2
    s_cbranch_scc1 L_ob2
    s_cmp_eq_u32 s56, 3
    s_cbranch_scc1 L_ob3
    s_cmp_eq_u32 s56, 4
    s_cbranch_scc1 L_ob4
    s_cmp_eq_u32 s56, 5
    s_cbranch_scc1 L_ob5
    s_cmp_eq_u32 s56, 6
    s_cbranch_scc1 L_ob6
    s_branch L_ob7
L_odone:
    s_cmp_eq_u32 s51, 0
    s_nop 7
    s_mov_b32 s63, 0
    s_cbranch_scc1 L_ok0
    ds_write_b128 v146, v[80:83] offset:0
    ds_write_b128 v146, v[84:87] offset:1024
    ds_write_b128 v146, v[88:91] offset:2048
    ds_write_b128 v146, v[92:95] offset:3072
    ds_write_b32 v148, v150
L_ow1:
    ds_read_b32 v7, v149
    ds_read_b128 v[16:19], v147 offset:0
    ds_read_b128 v[20:23], v147 offset:1024
    ds_read_b128 v[24:27], v147 offset:2048
    ds_read_b128 v[28:31], v147 offset:3072
    s_add_u32 s63, s63, 1
    s_waitcnt lgkmcnt(4)
    v_cmp_eq_u32 vcc, 0, v7
    s_cmp_ge_u32 s63, 16000000
    s_cbranch_scc1 L_og1
    s_cbranch_vccnz L_ow1
L_og1:
    s_waitcnt lgkmcnt(2)
    v_pk_add_f32 v[96:97], v[96:97], v[16:17]
    v_pk_add_f32 v[98:99], v[98:99], v[18:19]
    v_pk_add_f32 v[100:101], v[100:101], v[20:21]
    v_pk_add_f32 v[102:103], v[102:103], v[22:23]
    v_cvt_pk_bf16_f32 v32, v96, v97
    v_cvt_pk_bf16_f32 v33, v98, v99
    v_cvt_pk_bf16_f32 v34, v100, v101
    v_cvt_pk_bf16_f32 v35, v102, v103
    buffer_store_dwordx4 v[32:35], v151, s[24:27], s55 offen offset:0
    s_waitcnt lgkmcnt(0)
    v_pk_add_f32 v[104:105], v[104:105], v[24:25]
    v_pk_add_f32 v[106:107], v[106:107], v[26:27]
    v_pk_add_f32 v[108:109], v[108:109], v[28:29]
    v_pk_add_f32 v[110:111], v[110:111], v[30:31]
    v_cvt_pk_bf16_f32 v36, v104, v105
    v_cvt_pk_bf16_f32 v37, v106, v107
    v_cvt_pk_bf16_f32 v38, v108, v109
    v_cvt_pk_bf16_f32 v39, v110, v111
    buffer_store_dwordx4 v[36:39], v151, s[24:27], s55 offen offset:32
    s_branch L_oe
L_ok0:
    ds_write_b128 v146, v[96:99] offset:0
    ds_write_b128 v146, v[100:103] offset:1024
    ds_write_b128 v146, v[104:107] offset:2048
    ds_write_b128 v146, v[108:111] offset:3072
    ds_write_b32 v148, v150
L_ow0:
    ds_read_b32 v7, v149
    ds_read_b128 v[16:19], v147 offset:0
    ds_read_b128 v[20:23], v147 offset:1024
    ds_read_b128 v[24:27], v147 offset:2048
    ds_read_b128 v[28:31], v147 offset:3072
    s_add_u32 s63, s63, 1
    s_waitcnt lgkmcnt(4)
    v_cmp_eq_u32 vcc, 0, v7
    s_cmp_ge_u32 s63, 16000000
    s_cbranch_scc1 L_og0
    s_cbranch_vccnz L_ow0
L_og0:
    s_waitcnt lgkmcnt(2)
    v_pk_add_f32 v[80:81], v[80:81], v[16:17]
    v_pk_add_f32 v[82:83], v[82:83], v[18:19]
    v_pk_add_f32 v[84:85], v[84:85], v[20:21]
    v_pk_add_f32 v[86:87], v[86:87], v[22:23]
    v_cvt_pk_bf16_f32 v32, v80, v81
    v_cvt_pk_bf16_f32 v33, v82, v83
    v_cvt_pk_bf16_f32 v34, v84, v85
    v_cvt_pk_bf16_f32 v35, v86, v87
    buffer_store_dwordx4 v[32:35], v151, s[24:27], s55 offen offset:0
    s_waitcnt lgkmcnt(0)
    v_pk_add_f32 v[88:89], v[88:89], v[24:25]
    v_pk_add_f32 v[90:91], v[90:91], v[26:27]
    v_pk_add_f32 v[92:93], v[92:93], v[28:29]
    v_pk_add_f32 v[94:95], v[94:95], v[30:31]
    v_cvt_pk_bf16_f32 v36, v88, v89
    v_cvt_pk_bf16_f32 v37, v90, v91
    v_cvt_pk_bf16_f32 v38, v92, v93
    v_cvt_pk_bf16_f32 v39, v94, v95
    buffer_store_dwordx4 v[36:39], v151, s[24:27], s55 offen offset:32
L_oe:
    s_branch L_end
L_comp:
    s_waitcnt lgkmcnt(0)
    s_mov_b32 s20, s80
    s_mov_b32 s21, s81
    s_mov_b32 s22, 15679488
    s_mov_b32 s23, 0x20000
    s_mov_b32 s28, s78
    s_mov_b32 s29, s79
    s_mov_b32 s30, 256
    s_mov_b32 s31, 0x20000
    s_mov_b32 s24, s76
    s_mov_b32 s25, s77
    s_mov_b32 s26, 3670016
    s_mov_b32 s27, 0x20000
    s_and_b32 s51, s2, 7
    s_lshl_b32 s34, s51, 1
    s_bfe_u32 s36, s2, 0x10003
    s_add_u32 s34, s34, s36
    s_lshr_b32 s35, s2, 4
    s_mul_i32 s37, s34, 7
    s_lshr_b32 s37, s37, 1
    s_lshl_b32 s37, s37, 9
    s_lshr_b32 s52, s2, 3
    s_cmp_lt_u32 s52, 28
    s_cselect_b32 s45, 1, 0
    s_mul_i32 s43, s52, 37
    s_lshr_b32 s43, s43, 8
    s_mul_i32 s53, s43, 7
    s_sub_u32 s44, s52, s53
    s_lshl_b32 s51, s51, 2
    s_add_u32 s43, s43, s51
    s_min_u32 s43, s43, 31
    s_cmp_eq_u32 s36, 0
    s_cselect_b32 s46, 0x0fffffff, -16
    s_mov_b32 s47, s46
    s_cselect_b32 s48, 0, -1
    s_cselect_b32 s49, -1, 0
    v_and_b32 v1, 31, v0
    v_lshrrev_b32 v2, 5, v0
    v_and_b32 v3, 51, v0
    v_bfe_u32 v4, v0, 2, 1
    v_lshl_add_u32 v3, v4, 3, v3
    v_bfe_u32 v4, v0, 3, 1
    v_lshl_add_u32 v3, v4, 2, v3
    v_lshlrev_b32 v5, 4, v3
    v_lshlrev_b32 v6, 4, v0
    s_mov_b32 s64, s48
    s_mov_b32 s65, s48
    s_mov_b32 s66, s48
    s_mov_b32 s67, 0
    s_mov_b32 s70, 0
    s_mov_b32 s71, s49
    v_mov_b32 v162, 0
    s_cmp_eq_u32 s3, 4
    s_cbranch_scc0 L_nopf
    s_getpc_b64 s[52:53]
L_pc:
    s_lshr_b32 s51, s2, 3
    s_lshl_b32 s51, s51, 10
    v_add_u32 v7, s51, v6
    s_sub_u32 s52, s52, L_pc - L_begin
    s_subb_u32 s53, s53, 0
    v_cmp_gt_u32 vcc, L_codeend - L_begin - 12, v7
    s_nop 0
    s_and_saveexec_b64 s[54:55], vcc
    s_cbranch_execz L_pfe
    global_load_dwordx4 v[136:139], v7, s[52:53]
L_pfe:
    s_mov_b64 exec, -1
L_nopf:
    s_cmp_eq_u32 s42, 0
    s_cbranch_scc1 L_gidle
    v_lshrrev_b32 v4, 1, v1
    v_and_b32 v4, 7, v4
    v_xor_b32 v4, v4, v2
    v_lshlrev_b32 v4, 4, v4
    v_lshl_add_u32 v8, v1, 7, v4
    v_xor_b32 v9, 32, v8
    v_xor_b32 v10, 64, v8
    v_xor_b32 v11, 96, v8
    s_and_b32 s51, s3, 1
    v_lshrrev_b32 v7, 5, v0
    v_bfe_u32 v4, v0, 2, 2
    v_lshl_add_u32 v12, v7, 3, v4
    v_lshlrev_b32 v12, 7, v12
    v_lshrrev_b32 v4, 1, v4
    v_xor_b32 v4, s51, v4
    v_lshl_add_u32 v12, v4, 6, v12
    v_bfe_u32 v4, v0, 4, 1
    v_lshl_add_u32 v12, v4, 5, v12
    v_and_b32 v4, 1, v0
    v_lshl_add_u32 v12, v4, 4, v12
    v_bfe_u32 v4, v0, 1, 1
    v_lshl_add_u32 v12, v4, 3, v12
    s_bfe_u32 s51, s3, 0x10001
    s_lshl_b32 s51, s51, 13
    s_add_u32 s51, s51, 12288
    v_add_u32 v12, s51, v12
    s_add_u32 s51, s41, s50
    s_cmp_eq_u32 s38, 21
    s_cselect_b32 s55, 2, 0
    s_cmp_eq_u32 s39, 10
    s_cselect_b32 s56, 2, 0
    s_cmp_lt_u32 s50, s56
    s_cselect_b32 s55, 3, s55
    s_lshr_b32 s57, s40, 5
    s_cmp_ge_u32 s3, 4
    s_cselect_b32 s58, 5505024, 0
    s_cselect_b32 s59, 172032, 0
    s_cselect_b32 s52, 86016, 0
    s_add_u32 s59, s59, 15204352
    s_lshl_b32 s60, s51, 12
    s_add_u32 s59, s59, s60
    s_lshl_b32 s60, s38, 7
    s_add_u32 s59, s59, s60
    v_mov_b32 v88, 0
    v_mov_b32 v89, 0
    v_pk_mov_b32 v[90:91], v[88:89], v[88:89]
    v_pk_mov_b32 v[92:93], v[88:89], v[88:89]
    v_pk_mov_b32 v[94:95], v[88:89], v[88:89]
    v_pk_mov_b32 v[96:97], v[88:89], v[88:89]
    v_pk_mov_b32 v[98:99], v[88:89], v[88:89]
    v_pk_mov_b32 v[100:101], v[88:89], v[88:89]
    v_pk_mov_b32 v[102:103], v[88:89], v[88:89]
    v_pk_mov_b32 v[104:105], v[88:89], v[88:89]
    v_pk_mov_b32 v[106:107], v[88:89], v[88:89]
    v_pk_mov_b32 v[108:109], v[88:89], v[88:89]
    v_pk_mov_b32 v[110:111], v[88:89], v[88:89]
    v_pk_mov_b32 v[112:113], v[88:89], v[88:89]
    v_pk_mov_b32 v[114:115], v[88:89], v[88:89]
    v_pk_mov_b32 v[116:117], v[88:89], v[88:89]
    v_pk_mov_b32 v[118:119], v[88:89], v[88:89]
    v_pk_mov_b32 v[120:121], v[88:89], v[88:89]
    v_pk_mov_b32 v[122:123], v[88:89], v[88:89]
    v_pk_mov_b32 v[124:125], v[88:89], v[88:89]
    v_pk_mov_b32 v[126:127], v[88:89], v[88:89]
    v_pk_mov_b32 v[128:129], v[88:89], v[88:89]
    v_pk_mov_b32 v[130:131], v[88:89], v[88:89]
    v_pk_mov_b32 v[132:133], v[88:89], v[88:89]
    v_pk_mov_b32 v[134:135], v[88:89], v[88:89]
    s_cmp_ge_u32 s51, 28
    s_cbranch_scc1 L_gV
L_gQK:
    v_mov_b32 v13, v6
    v_add_u32 v14, 1024, v6
    s_cmp_ge_u32 s51, 14
    s_cselect_b32 s53, 1806336, 0
    s_cselect_b32 s54, 1.0, 0x3e8b97f6
    s_lshl_b32 s60, s51, 11
    s_add_u32 s53, s53, s60
    s_mul_i32 s60, s57, 28672
    s_add_u32 s53, s53, s60
    s_mov_b32 s57, 28672
    v_mov_b32 v22, s54
    s_add_u32 s53, s53, s58
    v_add_u32 v16, s52, v8
    v_add_u32 v17, s52, v9
    v_add_u32 v18, s52, v10
    v_add_u32 v19, s52, v11
    v_add_u32 v20, s52, v12
    s_add_u32 s52, s52, 28672
    s_cmp_ge_u32 s52, 114688
    s_cselect_b32 s52, 0, s52
    s_cmp_ge_u32 s3, 4
    s_cbranch_scc0 L_gQK_go
    s_barrier
    s_barrier
    s_barrier
    s_barrier
    s_barrier
    s_barrier
    s_barrier
    s_waitcnt vmcnt(0)
L_gQK_go:
    s_barrier
    ds_read_b64_tr_b16 v[36:37], v20 offset:0
    ds_read_b64_tr_b16 v[38:39], v20 offset:512
    ds_read_b128 v[24:27], v16 offset:0
    ds_read_b128 v[28:31], v16 offset:4096
    ds_read_b128 v[32:35], v16 offset:8192
    ds_read_b64_tr_b16 v[52:53], v20 offset:2048
    ds_read_b64_tr_b16 v[54:55], v20 offset:2560
    ds_read_b128 v[40:43], v17 offset:0
    ds_read_b128 v[44:47], v17 offset:4096
    ds_read_b128 v[48:51], v17 offset:8192
    s_mov_b32 s56, 6
L_gQK_chunk:
    s_waitcnt lgkmcnt(5)
    v_mfma_f32_32x32x16_bf16 v[88:103], v[36:39], v[24:27], v[88:103]
    ds_read_b64_tr_b16 v[68:69], v20 offset:4096
    ds_read_b64_tr_b16 v[70:71], v20 offset:4608
    v_mfma_f32_32x32x16_bf16 v[104:119], v[36:39], v[28:31], v[104:119]
    ds_read_b128 v[56:59], v18 offset:0
    ds_read_b128 v[60:63], v18 offset:4096
    v_mfma_f32_32x32x16_bf16 v[120:135], v[36:39], v[32:35], v[120:135]
    ds_read_b128 v[64:67], v18 offset:8192
    s_waitcnt lgkmcnt(5)
    v_mfma_f32_32x32x16_bf16 v[88:103], v[52:55], v[40:43], v[88:103]
    ds_read_b64_tr_b16 v[84:85], v20 offset:6144
    ds_read_b64_tr_b16 v[86:87], v20 offset:6656
    ds_read_b128 v[72:75], v19 offset:0
    v_mfma_f32_32x32x16_bf16 v[104:119], v[52:55], v[44:47], v[104:119]
    ds_read_b128 v[76:79], v19 offset:4096
    ds_read_b128 v[80:83], v19 offset:8192
    v_mfma_f32_32x32x16_bf16 v[120:135], v[52:55], v[48:51], v[120:135]
    s_cmp_eq_u32 s56, 0
    s_cbranch_scc1 L_gQK_last
    s_waitcnt lgkmcnt(5)
    v_mfma_f32_32x32x16_bf16 v[88:103], v[68:71], v[56:59], v[88:103]
    v_add_u32 v16, s52, v8
    v_add_u32 v17, s52, v9
    v_add_u32 v18, s52, v10
    v_add_u32 v19, s52, v11
    v_add_u32 v20, s52, v12
    v_mfma_f32_32x32x16_bf16 v[104:119], v[68:71], v[60:63], v[104:119]
    s_add_u32 s52, s52, 28672
    s_cmp_ge_u32 s52, 114688
    s_cselect_b32 s52, 0, s52
    s_sub_u32 s56, s56, 1
    s_waitcnt lgkmcnt(0)
    s_barrier
    v_mfma_f32_32x32x16_bf16 v[120:135], v[68:71], v[64:67], v[120:135]
    ds_read_b64_tr_b16 v[36:37], v20 offset:0
    ds_read_b64_tr_b16 v[38:39], v20 offset:512
    ds_read_b128 v[24:27], v16 offset:0
    v_mfma_f32_32x32x16_bf16 v[88:103], v[84:87], v[72:75], v[88:103]
    ds_read_b128 v[28:31], v16 offset:4096
    ds_read_b128 v[32:35], v16 offset:8192
    v_mfma_f32_32x32x16_bf16 v[104:119], v[84:87], v[76:79], v[104:119]
    ds_read_b64_tr_b16 v[52:53], v20 offset:2048
    ds_read_b64_tr_b16 v[54:55], v20 offset:2560
    ds_read_b128 v[40:43], v17 offset:0
    v_mfma_f32_32x32x16_bf16 v[120:135], v[84:87], v[80:83], v[120:135]
    ds_read_b128 v[44:47], v17 offset:4096
    ds_read_b128 v[48:51], v17 offset:8192
    s_branch L_gQK_chunk
L_gQK_last:
    s_waitcnt lgkmcnt(0)
    v_mfma_f32_32x32x16_bf16 v[88:103], v[68:71], v[56:59], v[88:103]
    v_mfma_f32_32x32x16_bf16 v[88:103], v[84:87], v[72:75], v[88:103]
    v_mfma_f32_32x32x16_bf16 v[104:119], v[68:71], v[60:63], v[104:119]
    v_mfma_f32_32x32x16_bf16 v[104:119], v[84:87], v[76:79], v[104:119]
    v_mfma_f32_32x32x16_bf16 v[120:135], v[68:71], v[64:67], v[120:135]
    v_mfma_f32_32x32x16_bf16 v[120:135], v[84:87], v[80:83], v[120:135]
    s_nop 6
    s_branch L_gcvt
L_gV:
    v_and_b32 v4, 31, v3
    s_sub_u32 s60, s51, 28
    s_lshl_b32 s60, s60, 5
    v_add_u32 v4, s60, v4
    v_mul_u32_u24 v7, 2341, v4
    v_lshrrev_b32 v7, 16, v7
    v_mul_u32_u24 v13, 28, v7
    v_sub_u32 v4, v4, v13
    v_mul_u32_u24 v7, 114688, v7
    v_lshl_add_u32 v13, v4, 4, v7
    v_mul_u32_u24 v4, 448, v2
    v_add_u32 v13, v13, v4
    v_add_u32 v14, 896, v13
    s_mul_i32 s53, s57, 1792
    s_add_u32 s53, s53, 3670016
    s_mov_b32 s57, 1792
    v_mov_b32 v22, 0x4f800000
    s_add_u32 s53, s53, s58
    v_add_u32 v16, s52, v8
    v_add_u32 v17, s52, v9
    v_add_u32 v18, s52, v10
    v_add_u32 v19, s52, v11
    v_add_u32 v20, s52, v12
    s_add_u32 s52, s52, 28672
    s_cmp_ge_u32 s52, 114688
    s_cselect_b32 s52, 0, s52
    s_cmp_ge_u32 s3, 4
    s_cbranch_scc0 L_gV_go
    s_barrier
    s_barrier
    s_barrier
    s_barrier
    s_barrier
    s_barrier
    s_barrier
    s_waitcnt vmcnt(0)
L_gV_go:
    s_barrier
    ds_read_b64_tr_b16 v[36:37], v20 offset:0
    ds_read_b64_tr_b16 v[38:39], v20 offset:512
    ds_read_b128 v[24:27], v16 offset:0
    ds_read_b128 v[28:31], v16 offset:4096
    ds_read_b128 v[32:35], v16 offset:8192
    ds_read_b64_tr_b16 v[52:53], v20 offset:2048
    ds_read_b64_tr_b16 v[54:55], v20 offset:2560
    ds_read_b128 v[40:43], v17 offset:0
    ds_read_b128 v[44:47], v17 offset:4096
    ds_read_b128 v[48:51], v17 offset:8192
    s_mov_b32 s56, 6
L_gV_chunk:
    s_waitcnt lgkmcnt(5)
    v_mfma_f32_32x32x16_bf16 v[88:103], v[24:27], v[36:39], v[88:103]
    ds_read_b64_tr_b16 v[68:69], v20 offset:4096
    ds_read_b64_tr_b16 v[70:71], v20 offset:4608
    v_mfma_f32_32x32x16_bf16 v[104:119], v[28:31], v[36:39], v[104:119]
    ds_read_b128 v[56:59], v18 offset:0
    ds_read_b128 v[60:63], v18 offset:4096
    v_mfma_f32_32x32x16_bf16 v[120:135], v[32:35], v[36:39], v[120:135]
    ds_read_b128 v[64:67], v18 offset:8192
    s_waitcnt lgkmcnt(5)
    v_mfma_f32_32x32x16_bf16 v[88:103], v[40:43], v[52:55], v[88:103]
    ds_read_b64_tr_b16 v[84:85], v20 offset:6144
    ds_read_b64_tr_b16 v[86:87], v20 offset:6656
    ds_read_b128 v[72:75], v19 offset:0
    v_mfma_f32_32x32x16_bf16 v[104:119], v[44:47], v[52:55], v[104:119]
    ds_read_b128 v[76:79], v19 offset:4096
    ds_read_b128 v[80:83], v19 offset:8192
    v_mfma_f32_32x32x16_bf16 v[120:135], v[48:51], v[52:55], v[120:135]
    s_cmp_eq_u32 s56, 0
    s_cbranch_scc1 L_gV_last
    s_waitcnt lgkmcnt(5)
    v_mfma_f32_32x32x16_bf16 v[88:103], v[56:59], v[68:71], v[88:103]
    v_add_u32 v16, s52, v8
    v_add_u32 v17, s52, v9
    v_add_u32 v18, s52, v10
    v_add_u32 v19, s52, v11
    v_add_u32 v20, s52, v12
    v_mfma_f32_32x32x16_bf16 v[104:119], v[60:63], v[68:71], v[104:119]
    s_add_u32 s52, s52, 28672
    s_cmp_ge_u32 s52, 114688
    s_cselect_b32 s52, 0, s52
    s_sub_u32 s56, s56, 1
    s_waitcnt lgkmcnt(0)
    s_barrier
    v_mfma_f32_32x32x16_bf16 v[120:135], v[64:67], v[68:71], v[120:135]
    ds_read_b64_tr_b16 v[36:37], v20 offset:0
    ds_read_b64_tr_b16 v[38:39], v20 offset:512
    ds_read_b128 v[24:27], v16 offset:0
    v_mfma_f32_32x32x16_bf16 v[88:103], v[72:75], v[84:87], v[88:103]
    ds_read_b128 v[28:31], v16 offset:4096
    ds_read_b128 v[32:35], v16 offset:8192
    v_mfma_f32_32x32x16_bf16 v[104:119], v[76:79], v[84:87], v[104:119]
    ds_read_b64_tr_b16 v[52:53], v20 offset:2048
    ds_read_b64_tr_b16 v[54:55], v20 offset:2560
    ds_read_b128 v[40:43], v17 offset:0
    v_mfma_f32_32x32x16_bf16 v[120:135], v[80:83], v[84:87], v[120:135]
    ds_read_b128 v[44:47], v17 offset:4096
    ds_read_b128 v[48:51], v17 offset:8192
    s_branch L_gV_chunk
L_gV_last:
    s_waitcnt lgkmcnt(0)
    v_mfma_f32_32x32x16_bf16 v[88:103], v[56:59], v[68:71], v[88:103]
    v_mfma_f32_32x32x16_bf16 v[88:103], v[72:75], v[84:87], v[88:103]
    v_mfma_f32_32x32x16_bf16 v[104:119], v[60:63], v[68:71], v[104:119]
    v_mfma_f32_32x32x16_bf16 v[104:119], v[76:79], v[84:87], v[104:119]
    v_mfma_f32_32x32x16_bf16 v[120:135], v[64:67], v[68:71], v[120:135]
    v_mfma_f32_32x32x16_bf16 v[120:135], v[80:83], v[84:87], v[120:135]
    s_nop 7
L_gcvt:
    s_cmp_ge_u32 s3, 4
    s_cbranch_scc1 L_gnm0
    v_pk_mul_f32 v[88:89], v[88:89], v[22:23] op_sel_hi:[1,0]
    v_pk_mul_f32 v[90:91], v[90:91], v[22:23] op_sel_hi:[1,0]
    v_pk_mul_f32 v[92:93], v[92:93], v[22:23] op_sel_hi:[1,0]
    v_pk_mul_f32 v[94:95], v[94:95], v[22:23] op_sel_hi:[1,0]
    v_pk_mul_f32 v[96:97], v[96:97], v[22:23] op_sel_hi:[1,0]
    v_pk_mul_f32 v[98:99], v[98:99], v[22:23] op_sel_hi:[1,0]
    v_pk_mul_f32 v[100:101], v[100:101], v[22:23] op_sel_hi:[1,0]
    v_pk_mul_f32 v[102:103], v[102:103], v[22:23] op_sel_hi:[1,0]
L_gnm0:
    v_cvt_pk_bf16_f32 v136, v88, v89
    v_cvt_pk_bf16_f32 v137, v90, v91
    v_cvt_pk_bf16_f32 v138, v92, v93
    v_cvt_pk_bf16_f32 v139, v94, v95
    v_cvt_pk_bf16_f32 v140, v96, v97
    v_cvt_pk_bf16_f32 v141, v98, v99
    v_cvt_pk_bf16_f32 v142, v100, v101
    v_cvt_pk_bf16_f32 v143, v102, v103
    s_cmp_ge_u32 s3, 4
    s_cbranch_scc1 L_gns0
    s_cmp_gt_u32 s55, 0
    s_cbranch_scc1 gs_5
    buffer_store_dwordx4 v[136:139], v13, s[20:23], s53 offen sc1
    buffer_store_dwordx4 v[140:143], v14, s[20:23], s53 offen sc1
gs_5:
    s_add_u32 s53, s53, s57
L_gns0:
    s_cmp_ge_u32 s3, 4
    s_cbranch_scc1 L_gnm1
    v_pk_mul_f32 v[104:105], v[104:105], v[22:23] op_sel_hi:[1,0]
    v_pk_mul_f32 v[106:107], v[106:107], v[22:23] op_sel_hi:[1,0]
    v_pk_mul_f32 v[108:109], v[108:109], v[22:23] op_sel_hi:[1,0]
    v_pk_mul_f32 v[110:111], v[110:111], v[22:23] op_sel_hi:[1,0]
    v_pk_mul_f32 v[112:113], v[112:113], v[22:23] op_sel_hi:[1,0]
    v_pk_mul_f32 v[114:115], v[114:115], v[22:23] op_sel_hi:[1,0]
    v_pk_mul_f32 v[116:117], v[116:117], v[22:23] op_sel_hi:[1,0]
    v_pk_mul_f32 v[118:119], v[118:119], v[22:23] op_sel_hi:[1,0]
L_gnm1:
    v_cvt_pk_bf16_f32 v144, v104, v105
    v_cvt_pk_bf16_f32 v145, v106, v107
    v_cvt_pk_bf16_f32 v146, v108, v109
    v_cvt_pk_bf16_f32 v147, v110, v111
    v_cvt_pk_bf16_f32 v148, v112, v113
    v_cvt_pk_bf16_f32 v149, v114, v115
    v_cvt_pk_bf16_f32 v150, v116, v117
    v_cvt_pk_bf16_f32 v151, v118, v119
    s_cmp_ge_u32 s3, 4
    s_cbranch_scc1 L_gns1
    s_cmp_gt_u32 s55, 1
    s_cbranch_scc1 gs_6
    buffer_store_dwordx4 v[144:147], v13, s[20:23], s53 offen sc1
    buffer_store_dwordx4 v[148:151], v14, s[20:23], s53 offen sc1
gs_6:
    s_add_u32 s53, s53, s57
L_gns1:
    s_cmp_ge_u32 s3, 4
    s_cbranch_scc1 L_gnm2
    v_pk_mul_f32 v[120:121], v[120:121], v[22:23] op_sel_hi:[1,0]
    v_pk_mul_f32 v[122:123], v[122:123], v[22:23] op_sel_hi:[1,0]
    v_pk_mul_f32 v[124:125], v[124:125], v[22:23] op_sel_hi:[1,0]
    v_pk_mul_f32 v[126:127], v[126:127], v[22:23] op_sel_hi:[1,0]
    v_pk_mul_f32 v[128:129], v[128:129], v[22:23] op_sel_hi:[1,0]
    v_pk_mul_f32 v[130:131], v[130:131], v[22:23] op_sel_hi:[1,0]
    v_pk_mul_f32 v[132:133], v[132:133], v[22:23] op_sel_hi:[1,0]
    v_pk_mul_f32 v[134:135], v[134:135], v[22:23] op_sel_hi:[1,0]
L_gnm2:
    v_cvt_pk_bf16_f32 v152, v120, v121
    v_cvt_pk_bf16_f32 v153, v122, v123
    v_cvt_pk_bf16_f32 v154, v124, v125
    v_cvt_pk_bf16_f32 v155, v126, v127
    v_cvt_pk_bf16_f32 v156, v128, v129
    v_cvt_pk_bf16_f32 v157, v130, v131
    v_cvt_pk_bf16_f32 v158, v132, v133
    v_cvt_pk_bf16_f32 v159, v134, v135
    s_cmp_ge_u32 s3, 4
    s_cbranch_scc1 L_att
    s_cmp_gt_u32 s55, 2
    s_cbranch_scc1 gs_7
    buffer_store_dwordx4 v[152:155], v13, s[20:23], s53 offen sc1
    buffer_store_dwordx4 v[156:159], v14, s[20:23], s53 offen sc1
gs_7:
    s_add_u32 s53, s53, s57
    buffer_load_dwordx2 v[160:161], v162, s[28:31], 0 offen sc1
L_gns2:
    s_barrier
    s_waitcnt vmcnt(0)
    s_mov_b32 s63, 0
non_9:
    v_readfirstlane_b32 s32, v160
    v_readfirstlane_b32 s33, v161
    s_add_u32 s63, s63, 1
    s_cmp_lg_u32 s33, 0
    s_cbranch_scc1 non_9_ok
    s_cmp_ge_u32 s63, 2000000
    s_cbranch_scc1 non_9_ok
    s_sleep 8
    buffer_load_dwordx2 v[160:161], v162, s[28:31], 0 offen sc1
    s_waitcnt vmcnt(0)
    s_branch non_9
non_9_ok:
    s_cmp_eq_u32 s55, 3
    s_cbranch_scc1 gp_8
    s_mov_b64 exec, 1
    buffer_store_dwordx2 v[160:161], v162, s[20:23], s59 offen sc1
    s_mov_b64 exec, -1
gp_8:
    s_barrier
    s_barrier
    s_barrier
    s_barrier
    s_barrier
    v_and_b32 v7, 3, v0
    v_cmp_eq_u32 vcc, 0, v7
    v_mov_b32 v12, 0x4f804f80
    s_lshl_b32 s51, s50, 12
    v_cndmask_b32 v8, 0, v12, vcc
    s_cmp_eq_u32 s36, 0
    s_cselect_b32 s60, 448, 0
    s_add_u32 s51, s51, s60
    s_add_u32 s51, s51, 67584
    v_mov_b32 v9, v8
    v_mov_b32 v10, v8
    v_mov_b32 v11, v8
    v_lshl_add_u32 v7, v7, 4, s51
    v_bfe_u32 v12, v0, 2, 2
    v_lshl_add_u32 v7, v12, 9, v7
    v_lshrrev_b32 v12, 4, v0
    v_lshl_add_u32 v7, v12, 14, v7
    v_add_u32 v12, 0x10000, v7
    ds_write_b128 v7, v[8:11]
    s_mov_b32 exec_hi, 0
    ds_write_b128 v12, v[8:11]
    s_mov_b32 exec_hi, -1
    s_barrier
    s_branch L_att
L_gidle:
    s_waitcnt vmcnt(0)
    s_mov_b32 s55, 3
    v_mov_b32 v13, 0
    v_mov_b32 v14, 0
    s_barrier
    s_cmp_ge_u32 s3, 4
    s_cbranch_scc1 L_gidle1
    v_and_b32 v7, 3, v0
    v_cmp_eq_u32 vcc, 0, v7
    v_mov_b32 v12, 0x4f804f80
    s_lshl_b32 s51, s50, 12
    v_cndmask_b32 v8, 0, v12, vcc
    s_cmp_eq_u32 s36, 0
    s_cselect_b32 s60, 448, 0
    s_add_u32 s51, s51, s60
    s_add_u32 s51, s51, 67584
    v_mov_b32 v9, v8
    v_mov_b32 v10, v8
    v_mov_b32 v11, v8
    v_lshl_add_u32 v7, v7, 4, s51
    v_bfe_u32 v12, v0, 2, 2
    v_lshl_add_u32 v7, v12, 9, v7
    v_lshrrev_b32 v12, 4, v0
    v_lshl_add_u32 v7, v12, 14, v7
    v_add_u32 v12, 0x10000, v7
    ds_write_b128 v7, v[8:11]
    s_mov_b32 exec_hi, 0
    ds_write_b128 v12, v[8:11]
    s_mov_b32 exec_hi, -1
    s_branch L_att
L_gidle1:
L_att:
    v_mov_b32 v104, 0xdddddddd
    s_lshr_b32 s51, s3, 2
    s_lshl_b32 s51, s51, 13
    s_add_u32 s51, s51, 65536
    v_add_u32 v105, s51, v5
    v_add_u32 v106, 0x10000, v105
    s_lshl_b32 s51, s50, 11
    s_add_u32 s51, s51, 57344
    v_add_u32 v8, s51, v6
    v_mov_b32 v48, 0
    v_mov_b32 v49, 0
    v_pk_mov_b32 v[50:51], v[48:49], v[48:49]
    v_pk_mov_b32 v[52:53], v[48:49], v[48:49]
    v_pk_mov_b32 v[54:55], v[48:49], v[48:49]
    v_pk_mov_b32 v[56:57], v[48:49], v[48:49]
    v_pk_mov_b32 v[58:59], v[48:49], v[48:49]
    v_pk_mov_b32 v[60:61], v[48:49], v[48:49]
    v_pk_mov_b32 v[62:63], v[48:49], v[48:49]
    s_lshl_b32 s51, s3, 11
    s_add_u32 s51, s51, 114688
    v_add_u32 v107, s51, v6
    v_xor_b32 v124, 0x2000, v107
    s_lshl_b32 s51, s3, 8
    s_add_u32 s51, s51, 135168
    v_lshl_add_u32 v125, v0, 2, s51
    v_xor_b32 v126, 0x400, v125
    s_lshl_b32 s51, s50, 8
    v_lshl_add_u32 v9, v0, 2, s51
    s_waitcnt lgkmcnt(0)
    s_barrier
L_att0:
    ds_read_b128 v[80:83], v8
    ds_read_b128 v[84:87], v8 offset:1024
    ds_read_b128 v[88:91], v105 offset:32768
    ds_read_b128 v[92:95], v105 offset:33792
    ds_read_b128 v[96:99], v105 offset:34816
    s_waitcnt lgkmcnt(3)
    v_cndmask_b32 v80, v80, 0, s[66:67]
    v_cndmask_b32 v81, v81, 0, s[66:67]
    v_cndmask_b32 v86, v86, 0, s[70:71]
    v_cndmask_b32 v87, v87, 0, s[70:71]
    s_waitcnt lgkmcnt(1)
    s_nop 0
    v_mfma_f32_32x32x16_bf16 v[16:31], v[88:91], v[80:83], 0
    v_mfma_f32_32x32x16_bf16 v[16:31], v[92:95], v[84:87], v[16:31]
    ds_read_b128 v[88:91], v105 offset:36864
    ds_read_b128 v[92:95], v105 offset:37888
    s_cmp_ge_u32 s3, 4
    s_cbranch_scc1 L_g1m
    s_nop 7
    v_max3_f32 v7, v16, v17, v18
    v_max3_f32 v8, v19, v20, v21
    v_max3_f32 v7, v7, v22, v23
    v_max3_f32 v8, v8, v24, v25
    v_max3_f32 v7, v7, v26, v27
    v_max3_f32 v8, v8, v28, v29
    v_max3_f32 v7, v7, v30, v31
    v_max_f32 v7, v7, v8
    v_mov_b32 v8, v7
    s_nop 1
    v_permlane32_swap_b32 v7, v8
    v_max_f32 v7, v7, v8
    v_sub_f32 v64, 0xc2d00000, v7
    ds_write_b32 v9, v64
    s_branch L_havem
L_g1m:
    s_setprio 3
    s_cmp_gt_u32 s55, 0
    s_cbranch_scc1 gs_10
    buffer_store_dwordx4 v[136:139], v13, s[20:23], s53 offen sc1
    buffer_store_dwordx4 v[140:143], v14, s[20:23], s53 offen sc1
gs_10:
    s_add_u32 s53, s53, s57
    s_cmp_gt_u32 s55, 1
    s_cbranch_scc1 gs_11
    buffer_store_dwordx4 v[144:147], v13, s[20:23], s53 offen sc1
    buffer_store_dwordx4 v[148:151], v14, s[20:23], s53 offen sc1
gs_11:
    s_add_u32 s53, s53, s57
    s_barrier
    ds_read_b32 v64, v9
    s_waitcnt lgkmcnt(0)
L_havem:
    v_mov_b32 v65, v64
    v_pk_add_f32 v[16:17], v[16:17], v[64:65]
    v_pk_add_f32 v[18:19], v[18:19], v[64:65]
    v_pk_add_f32 v[20:21], v[20:21], v[64:65]
    v_pk_add_f32 v[22:23], v[22:23], v[64:65]
    v_pk_add_f32 v[24:25], v[24:25], v[64:65]
    v_pk_add_f32 v[26:27], v[26:27], v[64:65]
    v_pk_add_f32 v[28:29], v[28:29], v[64:65]
    v_pk_add_f32 v[30:31], v[30:31], v[64:65]
    v_pk_mov_b32 v[66:67], v[64:65], v[64:65]
    v_pk_mov_b32 v[68:69], v[64:65], v[64:65]
    v_pk_mov_b32 v[70:71], v[64:65], v[64:65]
    v_pk_mov_b32 v[72:73], v[64:65], v[64:65]
    v_pk_mov_b32 v[74:75], v[64:65], v[64:65]
    v_pk_mov_b32 v[76:77], v[64:65], v[64:65]
    v_pk_mov_b32 v[78:79], v[64:65], v[64:65]
    v_exp_f32 v16, v16
    v_exp_f32 v17, v17
    ds_read_b128 v[100:103], v105 offset:35840
    v_exp_f32 v18, v18
    v_exp_f32 v19, v19
    v_exp_f32 v20, v20
    s_waitcnt lgkmcnt(1)
    v_mfma_f32_32x32x16_bf16 v[32:47], v[88:91], v[80:83], v[64:79]
    v_exp_f32 v21, v21
    v_exp_f32 v22, v22
    v_exp_f32 v23, v23
    v_mfma_f32_32x32x16_bf16 v[32:47], v[92:95], v[84:87], v[32:47]
    s_cmp_ge_u32 s3, 4
    s_cbranch_scc1 L_nb0
    s_barrier
L_nb0:
    s_setprio 2
    ds_read_b128 v[88:91], v105 offset:49152
    ds_read_b128 v[92:95], v105 offset:50176
    v_exp_f32 v24, v24
    v_exp_f32 v25, v25
    v_exp_f32 v26, v26
    v_exp_f32 v27, v27
    s_waitcnt lgkmcnt(3)
    v_smfmac_f32_32x32x32_bf16 v[48:63], v[96:99], v[16:23], v104
    ds_read_b128 v[96:99], v105 offset:38912
    v_exp_f32 v28, v28
    v_exp_f32 v29, v29
    v_exp_f32 v30, v30
    v_exp_f32 v31, v31
    s_setprio 2
    v_exp_f32 v32, v32
    v_exp_f32 v33, v33
    s_waitcnt lgkmcnt(3)
    v_smfmac_f32_32x32x32_bf16 v[48:63], v[100:103], v[24:31], v104
    ds_read_b128 v[100:103], v105 offset:39936
    v_exp_f32 v34, v34
    v_exp_f32 v35, v35
    v_exp_f32 v36, v36
    s_waitcnt lgkmcnt(2)
    v_mfma_f32_32x32x16_bf16 v[16:31], v[88:91], v[80:83], v[64:79]
    v_exp_f32 v37, v37
    v_exp_f32 v38, v38
    v_exp_f32 v39, v39
    v_mfma_f32_32x32x16_bf16 v[16:31], v[92:95], v[84:87], v[16:31]
    ds_read_b128 v[88:91], v105 offset:53248
    ds_read_b128 v[92:95], v105 offset:54272
    v_exp_f32 v40, v40
    v_exp_f32 v41, v41
    v_exp_f32 v42, v42
    v_exp_f32 v43, v43
    s_waitcnt lgkmcnt(3)
    v_smfmac_f32_32x32x32_bf16 v[48:63], v[96:99], v[32:39], v104
    ds_read_b128 v[96:99], v105 offset:51200
    s_cmp_ge_u32 s3, 4
    s_cbranch_scc0 g1_12
    s_cmp_gt_u32 s55, 2
    s_cbranch_scc1 gs_13
    buffer_store_dwordx4 v[152:155], v13, s[20:23], s53 offen sc1
    buffer_store_dwordx4 v[156:159], v14, s[20:23], s53 offen sc1
gs_13:
    s_add_u32 s53, s53, s57
    buffer_load_dwordx2 v[160:161], v162, s[28:31], 0 offen sc1
g1_12:
    v_exp_f32 v44, v44
    v_exp_f32 v45, v45
    v_exp_f32 v46, v46
    v_exp_f32 v47, v47
    s_setprio 1
    v_exp_f32 v16, v16
    v_exp_f32 v17, v17
    s_waitcnt lgkmcnt(3)
    v_smfmac_f32_32x32x32_bf16 v[48:63], v[100:103], v[40:47], v104
    ds_read_b128 v[100:103], v105 offset:52224
    v_exp_f32 v18, v18
    v_exp_f32 v19, v19
    v_exp_f32 v20, v20
    s_waitcnt lgkmcnt(2)
    v_mfma_f32_32x32x16_bf16 v[32:47], v[88:91], v[80:83], v[64:79]
    v_exp_f32 v21, v21
    v_exp_f32 v22, v22
    v_exp_f32 v23, v23
    v_mfma_f32_32x32x16_bf16 v[32:47], v[92:95], v[84:87], v[32:47]
    ds_read_b128 v[88:91], v106 offset:0
    ds_read_b128 v[92:95], v106 offset:1024
    v_exp_f32 v24, v24
    v_exp_f32 v25, v25
    v_exp_f32 v26, v26
    v_exp_f32 v27, v27
    s_waitcnt lgkmcnt(3)
    v_smfmac_f32_32x32x32_bf16 v[48:63], v[96:99], v[16:23], v104
    ds_read_b128 v[96:99], v105 offset:55296
    v_exp_f32 v28, v28
    v_exp_f32 v29, v29
    v_exp_f32 v30, v30
    v_exp_f32 v31, v31
    s_setprio 0
    v_exp_f32 v32, v32
    v_exp_f32 v33, v33
    s_waitcnt lgkmcnt(3)
    v_smfmac_f32_32x32x32_bf16 v[48:63], v[100:103], v[24:31], v104
    ds_read_b128 v[100:103], v105 offset:56320
    v_exp_f32 v34, v34
    v_exp_f32 v35, v35
    v_exp_f32 v36, v36
    s_waitcnt lgkmcnt(2)
    v_mfma_f32_32x32x16_bf16 v[16:31], v[88:91], v[80:83], v[64:79]
    v_exp_f32 v37, v37
    v_exp_f32 v38, v38
    v_exp_f32 v39, v39
    v_mfma_f32_32x32x16_bf16 v[16:31], v[92:95], v[84:87], v[16:31]
    ds_read_b128 v[88:91], v106 offset:4096
    ds_read_b128 v[92:95], v106 offset:5120
    v_exp_f32 v40, v40
    v_exp_f32 v41, v41
    v_exp_f32 v42, v42
    v_exp_f32 v43, v43
    s_waitcnt lgkmcnt(3)
    v_smfmac_f32_32x32x32_bf16 v[48:63], v[96:99], v[32:39], v104
    ds_read_b128 v[96:99], v106 offset:2048
    v_exp_f32 v44, v44
    v_exp_f32 v45, v45
    v_exp_f32 v46, v46
    v_exp_f32 v47, v47
    s_setprio 0
    v_exp_f32 v16, v16
    v_exp_f32 v17, v17
    s_waitcnt lgkmcnt(3)
    v_smfmac_f32_32x32x32_bf16 v[48:63], v[100:103], v[40:47], v104
    ds_read_b128 v[100:103], v106 offset:3072
    v_exp_f32 v18, v18
    v_exp_f32 v19, v19
    v_exp_f32 v20, v20
    s_waitcnt lgkmcnt(2)
    v_mfma_f32_32x32x16_bf16 v[32:47], v[88:91], v[80:83], v[64:79]
    v_exp_f32 v21, v21
    v_exp_f32 v22, v22
    v_exp_f32 v23, v23
    v_mfma_f32_32x32x16_bf16 v[32:47], v[92:95], v[84:87], v[32:47]
    s_barrier
    s_setprio 2
    ds_read_b128 v[88:91], v106 offset:16384
    ds_read_b128 v[92:95], v106 offset:17408
    v_exp_f32 v24, v24
    v_exp_f32 v25, v25
    v_exp_f32 v26, v26
    v_exp_f32 v27, v27
    s_waitcnt lgkmcnt(3)
    v_smfmac_f32_32x32x32_bf16 v[48:63], v[96:99], v[16:23], v104
    ds_read_b128 v[96:99], v106 offset:6144
    v_exp_f32 v28, v28
    v_exp_f32 v29, v29
    v_exp_f32 v30, v30
    v_exp_f32 v31, v31
    s_setprio 2
    v_exp_f32 v32, v32
    v_exp_f32 v33, v33
    s_waitcnt lgkmcnt(3)
    v_smfmac_f32_32x32x32_bf16 v[48:63], v[100:103], v[24:31], v104
    ds_read_b128 v[100:103], v106 offset:7168
    v_exp_f32 v34, v34
    v_exp_f32 v35, v35
    v_exp_f32 v36, v36
    s_waitcnt lgkmcnt(2)
    v_mfma_f32_32x32x16_bf16 v[16:31], v[88:91], v[80:83], v[64:79]
    v_exp_f32 v37, v37
    v_exp_f32 v38, v38
    v_exp_f32 v39, v39
    v_mfma_f32_32x32x16_bf16 v[16:31], v[92:95], v[84:87], v[16:31]
    ds_read_b128 v[88:91], v106 offset:20480
    ds_read_b128 v[92:95], v106 offset:21504
    v_exp_f32 v40, v40
    v_exp_f32 v41, v41
    v_exp_f32 v42, v42
    v_exp_f32 v43, v43
    s_waitcnt lgkmcnt(3)
    v_smfmac_f32_32x32x32_bf16 v[48:63], v[96:99], v[32:39], v104
    ds_read_b128 v[96:99], v106 offset:18432
    s_cmp_ge_u32 s3, 4
    s_cbranch_scc0 g1_14
    s_waitcnt vmcnt(0)
    s_mov_b32 s63, 0
non_16:
    v_readfirstlane_b32 s32, v160
    v_readfirstlane_b32 s33, v161
    s_add_u32 s63, s63, 1
    s_cmp_lg_u32 s33, 0
    s_cbranch_scc1 non_16_ok
    s_cmp_ge_u32 s63, 2000000
    s_cbranch_scc1 non_16_ok
    s_sleep 8
    buffer_load_dwordx2 v[160:161], v162, s[28:31], 0 offen sc1
    s_waitcnt vmcnt(0)
    s_branch non_16
non_16_ok:
    s_cmp_eq_u32 s55, 3
    s_cbranch_scc1 gp_15
    s_mov_b64 exec, 1
    buffer_store_dwordx2 v[160:161], v162, s[20:23], s59 offen sc1
    s_mov_b64 exec, -1
gp_15:
g1_14:
    v_exp_f32 v44, v44
    v_exp_f32 v45, v45
    v_exp_f32 v46, v46
    v_exp_f32 v47, v47
    s_setprio 1
    v_exp_f32 v16, v16
    v_exp_f32 v17, v17
    s_waitcnt lgkmcnt(3)
    v_smfmac_f32_32x32x32_bf16 v[48:63], v[100:103], v[40:47], v104
    ds_read_b128 v[100:103], v106 offset:19456
    v_exp_f32 v18, v18
    v_exp_f32 v19, v19
    v_exp_f32 v20, v20
    s_waitcnt lgkmcnt(2)
    v_mfma_f32_32x32x16_bf16 v[32:47], v[88:91], v[80:83], v[64:79]
    v_exp_f32 v21, v21
    v_exp_f32 v22, v22
    v_exp_f32 v23, v23
    v_mfma_f32_32x32x16_bf16 v[32:47], v[92:95], v[84:87], v[32:47]
    ds_read_b128 v[88:91], v105 offset:0
    ds_read_b128 v[92:95], v105 offset:1024
    v_exp_f32 v24, v24
    v_exp_f32 v25, v25
    v_exp_f32 v26, v26
    v_exp_f32 v27, v27
    s_waitcnt lgkmcnt(3)
    v_smfmac_f32_32x32x32_bf16 v[48:63], v[96:99], v[16:23], v104
    ds_read_b128 v[96:99], v106 offset:22528
    v_exp_f32 v28, v28
    v_exp_f32 v29, v29
    v_exp_f32 v30, v30
    v_exp_f32 v31, v31
    s_setprio 0
    v_exp_f32 v32, v32
    v_exp_f32 v33, v33
    s_waitcnt lgkmcnt(3)
    v_smfmac_f32_32x32x32_bf16 v[48:63], v[100:103], v[24:31], v104
    ds_read_b128 v[100:103], v106 offset:23552
    v_exp_f32 v34, v34
    v_exp_f32 v35, v35
    v_exp_f32 v36, v36
    s_waitcnt lgkmcnt(2)
    v_mfma_f32_32x32x16_bf16 v[16:31], v[88:91], v[80:83], v[64:79]
    v_exp_f32 v37, v37
    v_exp_f32 v38, v38
    v_exp_f32 v39, v39
    v_mfma_f32_32x32x16_bf16 v[16:31], v[92:95], v[84:87], v[16:31]
    ds_read_b128 v[88:91], v105 offset:4096
    ds_read_b128 v[92:95], v105 offset:5120
    v_exp_f32 v40, v40
    v_exp_f32 v41, v41
    v_exp_f32 v42, v42
    v_exp_f32 v43, v43
    s_waitcnt lgkmcnt(3)
    v_smfmac_f32_32x32x32_bf16 v[48:63], v[96:99], v[32:39], v104
    ds_read_b128 v[96:99], v105 offset:2048
    v_exp_f32 v44, v44
    v_exp_f32 v45, v45
    v_exp_f32 v46, v46
    v_exp_f32 v47, v47
    s_setprio 0
    v_exp_f32 v16, v16
    v_exp_f32 v17, v17
    s_waitcnt lgkmcnt(3)
    v_smfmac_f32_32x32x32_bf16 v[48:63], v[100:103], v[40:47], v104
    ds_read_b128 v[100:103], v105 offset:3072
    v_exp_f32 v18, v18
    v_exp_f32 v19, v19
    v_exp_f32 v20, v20
    s_waitcnt lgkmcnt(2)
    v_mfma_f32_32x32x16_bf16 v[32:47], v[88:91], v[80:83], v[64:79]
    v_exp_f32 v21, v21
    v_exp_f32 v22, v22
    v_exp_f32 v23, v23
    v_mfma_f32_32x32x16_bf16 v[32:47], v[92:95], v[84:87], v[32:47]
    s_barrier
    s_setprio 2
    ds_read_b128 v[88:91], v105 offset:16384
    ds_read_b128 v[92:95], v105 offset:17408
    v_exp_f32 v24, v24
    v_exp_f32 v25, v25
    v_exp_f32 v26, v26
    v_exp_f32 v27, v27
    s_waitcnt lgkmcnt(3)
    v_smfmac_f32_32x32x32_bf16 v[48:63], v[96:99], v[16:23], v104
    ds_read_b128 v[96:99], v105 offset:6144
    v_exp_f32 v28, v28
    v_exp_f32 v29, v29
    v_exp_f32 v30, v30
    v_exp_f32 v31, v31
    s_setprio 2
    v_exp_f32 v32, v32
    v_exp_f32 v33, v33
    s_waitcnt lgkmcnt(3)
    v_smfmac_f32_32x32x32_bf16 v[48:63], v[100:103], v[24:31], v104
    ds_read_b128 v[100:103], v105 offset:7168
    v_exp_f32 v34, v34
    v_exp_f32 v35, v35
    v_exp_f32 v36, v36
    s_waitcnt lgkmcnt(2)
    v_mfma_f32_32x32x16_bf16 v[16:31], v[88:91], v[80:83], v[64:79]
    v_exp_f32 v37, v37
    v_exp_f32 v38, v38
    v_exp_f32 v39, v39
    v_mfma_f32_32x32x16_bf16 v[16:31], v[92:95], v[84:87], v[16:31]
    ds_read_b128 v[88:91], v105 offset:20480
    ds_read_b128 v[92:95], v105 offset:21504
    v_exp_f32 v40, v40
    v_exp_f32 v41, v41
    v_exp_f32 v42, v42
    v_exp_f32 v43, v43
    s_waitcnt lgkmcnt(3)
    v_smfmac_f32_32x32x32_bf16 v[48:63], v[96:99], v[32:39], v104
    ds_read_b128 v[96:99], v105 offset:18432
    v_exp_f32 v44, v44
    v_exp_f32 v45, v45
    v_exp_f32 v46, v46
    v_exp_f32 v47, v47
    s_setprio 1
    v_exp_f32 v16, v16
    v_exp_f32 v17, v17
    s_waitcnt lgkmcnt(3)
    v_smfmac_f32_32x32x32_bf16 v[48:63], v[100:103], v[40:47], v104
    ds_read_b128 v[100:103], v105 offset:19456
    v_exp_f32 v18, v18
    v_exp_f32 v19, v19
    v_exp_f32 v20, v20
    s_waitcnt lgkmcnt(2)
    v_mfma_f32_32x32x16_bf16 v[32:47], v[88:91], v[80:83], v[64:79]
    v_exp_f32 v21, v21
    v_exp_f32 v22, v22
    v_exp_f32 v23, v23
    v_mfma_f32_32x32x16_bf16 v[32:47], v[92:95], v[84:87], v[32:47]
    ds_read_b128 v[88:91], v105 offset:32768
    ds_read_b128 v[92:95], v105 offset:33792
    v_exp_f32 v24, v24
    v_exp_f32 v25, v25
    v_exp_f32 v26, v26
    v_exp_f32 v27, v27
    s_waitcnt lgkmcnt(3)
    v_smfmac_f32_32x32x32_bf16 v[48:63], v[96:99], v[16:23], v104
    ds_read_b128 v[96:99], v105 offset:22528
    v_exp_f32 v28, v28
    v_exp_f32 v29, v29
    v_exp_f32 v30, v30
    v_exp_f32 v31, v31
    s_setprio 0
    v_exp_f32 v32, v32
    v_exp_f32 v33, v33
    s_waitcnt lgkmcnt(3)
    v_smfmac_f32_32x32x32_bf16 v[48:63], v[100:103], v[24:31], v104
    ds_read_b128 v[100:103], v105 offset:23552
    v_exp_f32 v34, v34
    v_exp_f32 v35, v35
    v_exp_f32 v36, v36
    s_waitcnt lgkmcnt(2)
    v_mfma_f32_32x32x16_bf16 v[16:31], v[88:91], v[80:83], v[64:79]
    v_exp_f32 v37, v37
    v_exp_f32 v38, v38
    v_exp_f32 v39, v39
    v_mfma_f32_32x32x16_bf16 v[16:31], v[92:95], v[84:87], v[16:31]
    ds_read_b128 v[88:91], v105 offset:36864
    ds_read_b128 v[92:95], v105 offset:37888
    v_exp_f32 v40, v40
    v_exp_f32 v41, v41
    v_exp_f32 v42, v42
    v_exp_f32 v43, v43
    s_waitcnt lgkmcnt(3)
    v_smfmac_f32_32x32x32_bf16 v[48:63], v[96:99], v[32:39], v104
    ds_read_b128 v[96:99], v105 offset:34816
    v_exp_f32 v44, v44
    v_exp_f32 v45, v45
    v_exp_f32 v46, v46
    v_exp_f32 v47, v47
    s_setprio 0
    v_exp_f32 v16, v16
    v_exp_f32 v17, v17
    s_waitcnt lgkmcnt(3)
    v_smfmac_f32_32x32x32_bf16 v[48:63], v[100:103], v[40:47], v104
    ds_read_b128 v[100:103], v105 offset:35840
    v_exp_f32 v18, v18
    v_exp_f32 v19, v19
    v_exp_f32 v20, v20
    s_waitcnt lgkmcnt(2)
    v_mfma_f32_32x32x16_bf16 v[32:47], v[88:91], v[80:83], v[64:79]
    v_exp_f32 v21, v21
    v_exp_f32 v22, v22
    v_exp_f32 v23, v23
    v_mfma_f32_32x32x16_bf16 v[32:47], v[92:95], v[84:87], v[32:47]
    s_barrier
    s_setprio 2
    ds_read_b128 v[88:91], v105 offset:49152
    ds_read_b128 v[92:95], v105 offset:50176
    v_exp_f32 v24, v24
    v_exp_f32 v25, v25
    v_exp_f32 v26, v26
    v_exp_f32 v27, v27
    s_waitcnt lgkmcnt(3)
    v_smfmac_f32_32x32x32_bf16 v[48:63], v[96:99], v[16:23], v104
    ds_read_b128 v[96:99], v105 offset:38912
    v_exp_f32 v28, v28
    v_exp_f32 v29, v29
    v_exp_f32 v30, v30
    v_exp_f32 v31, v31
    s_setprio 2
    v_exp_f32 v32, v32
    v_exp_f32 v33, v33
    s_waitcnt lgkmcnt(3)
    v_smfmac_f32_32x32x32_bf16 v[48:63], v[100:103], v[24:31], v104
    ds_read_b128 v[100:103], v105 offset:39936
    v_exp_f32 v34, v34
    v_exp_f32 v35, v35
    v_exp_f32 v36, v36
    s_waitcnt lgkmcnt(2)
    v_mfma_f32_32x32x16_bf16 v[16:31], v[88:91], v[80:83], v[64:79]
    v_exp_f32 v37, v37
    v_exp_f32 v38, v38
    v_exp_f32 v39, v39
    v_mfma_f32_32x32x16_bf16 v[16:31], v[92:95], v[84:87], v[16:31]
    ds_read_b128 v[88:91], v105 offset:53248
    ds_read_b128 v[92:95], v105 offset:54272
    v_exp_f32 v40, v40
    v_exp_f32 v41, v41
    v_exp_f32 v42, v42
    v_exp_f32 v43, v43
    s_waitcnt lgkmcnt(3)
    v_smfmac_f32_32x32x32_bf16 v[48:63], v[96:99], v[32:39], v104
    ds_read_b128 v[96:99], v105 offset:51200
    v_exp_f32 v44, v44
    v_exp_f32 v45, v45
    v_exp_f32 v46, v46
    v_exp_f32 v47, v47
    s_setprio 1
    v_exp_f32 v16, v16
    v_exp_f32 v17, v17
    s_waitcnt lgkmcnt(3)
    v_smfmac_f32_32x32x32_bf16 v[48:63], v[100:103], v[40:47], v104
    ds_read_b128 v[100:103], v105 offset:52224
    v_exp_f32 v18, v18
    v_exp_f32 v19, v19
    v_exp_f32 v20, v20
    s_waitcnt lgkmcnt(2)
    v_mfma_f32_32x32x16_bf16 v[32:47], v[88:91], v[80:83], v[64:79]
    v_exp_f32 v21, v21
    v_exp_f32 v22, v22
    v_exp_f32 v23, v23
    v_mfma_f32_32x32x16_bf16 v[32:47], v[92:95], v[84:87], v[32:47]
    ds_read_b128 v[88:91], v106 offset:0
    ds_read_b128 v[92:95], v106 offset:1024
    v_exp_f32 v24, v24
    v_exp_f32 v25, v25
    v_exp_f32 v26, v26
    v_exp_f32 v27, v27
    s_waitcnt lgkmcnt(3)
    v_smfmac_f32_32x32x32_bf16 v[48:63], v[96:99], v[16:23], v104
    ds_read_b128 v[96:99], v105 offset:55296
    v_exp_f32 v28, v28
    v_exp_f32 v29, v29
    v_exp_f32 v30, v30
    v_exp_f32 v31, v31
    s_setprio 0
    v_exp_f32 v32, v32
    v_exp_f32 v33, v33
    s_waitcnt lgkmcnt(3)
    v_smfmac_f32_32x32x32_bf16 v[48:63], v[100:103], v[24:31], v104
    ds_read_b128 v[100:103], v105 offset:56320
    v_exp_f32 v34, v34
    v_exp_f32 v35, v35
    v_exp_f32 v36, v36
    s_waitcnt lgkmcnt(2)
    v_mfma_f32_32x32x16_bf16 v[16:31], v[88:91], v[80:83], v[64:79]
    v_exp_f32 v37, v37
    v_exp_f32 v38, v38
    v_exp_f32 v39, v39
    v_mfma_f32_32x32x16_bf16 v[16:31], v[92:95], v[84:87], v[16:31]
    ds_read_b128 v[88:91], v106 offset:4096
    ds_read_b128 v[92:95], v106 offset:5120
    v_exp_f32 v40, v40
    v_exp_f32 v41, v41
    v_exp_f32 v42, v42
    v_exp_f32 v43, v43
    s_waitcnt lgkmcnt(3)
    v_smfmac_f32_32x32x32_bf16 v[48:63], v[96:99], v[32:39], v104
    ds_read_b128 v[96:99], v106 offset:2048
    v_exp_f32 v44, v44
    v_exp_f32 v45, v45
    v_exp_f32 v46, v46
    v_exp_f32 v47, v47
    s_setprio 0
    v_exp_f32 v16, v16
    v_exp_f32 v17, v17
    s_waitcnt lgkmcnt(3)
    v_smfmac_f32_32x32x32_bf16 v[48:63], v[100:103], v[40:47], v104
    ds_read_b128 v[100:103], v106 offset:3072
    v_exp_f32 v18, v18
    v_exp_f32 v19, v19
    v_exp_f32 v20, v20
    s_waitcnt lgkmcnt(2)
    v_mfma_f32_32x32x16_bf16 v[32:47], v[88:91], v[80:83], v[64:79]
    v_exp_f32 v21, v21
    v_exp_f32 v22, v22
    v_exp_f32 v23, v23
    v_mfma_f32_32x32x16_bf16 v[32:47], v[92:95], v[84:87], v[32:47]
    s_barrier
    s_setprio 2
    ds_read_b128 v[88:91], v106 offset:16384
    ds_read_b128 v[92:95], v106 offset:17408
    v_exp_f32 v24, v24
    v_exp_f32 v25, v25
    v_exp_f32 v26, v26
    v_exp_f32 v27, v27
    s_waitcnt lgkmcnt(3)
    v_smfmac_f32_32x32x32_bf16 v[48:63], v[96:99], v[16:23], v104
    ds_read_b128 v[96:99], v106 offset:6144
    v_exp_f32 v28, v28
    v_exp_f32 v29, v29
    v_exp_f32 v30, v30
    v_exp_f32 v31, v31
    s_setprio 2
    v_exp_f32 v32, v32
    v_exp_f32 v33, v33
    s_waitcnt lgkmcnt(3)
    v_smfmac_f32_32x32x32_bf16 v[48:63], v[100:103], v[24:31], v104
    ds_read_b128 v[100:103], v106 offset:7168
    v_exp_f32 v34, v34
    v_exp_f32 v35, v35
    v_exp_f32 v36, v36
    s_waitcnt lgkmcnt(2)
    v_mfma_f32_32x32x16_bf16 v[16:31], v[88:91], v[80:83], v[64:79]
    v_exp_f32 v37, v37
    v_exp_f32 v38, v38
    v_exp_f32 v39, v39
    v_mfma_f32_32x32x16_bf16 v[16:31], v[92:95], v[84:87], v[16:31]
    ds_read_b128 v[88:91], v106 offset:20480
    ds_read_b128 v[92:95], v106 offset:21504
    v_exp_f32 v40, v40
    v_exp_f32 v41, v41
    v_exp_f32 v42, v42
    v_exp_f32 v43, v43
    s_waitcnt lgkmcnt(3)
    v_smfmac_f32_32x32x32_bf16 v[48:63], v[96:99], v[32:39], v104
    ds_read_b128 v[96:99], v106 offset:18432
    v_exp_f32 v44, v44
    v_exp_f32 v45, v45
    v_exp_f32 v46, v46
    v_exp_f32 v47, v47
    s_setprio 1
    v_exp_f32 v16, v16
    v_exp_f32 v17, v17
    s_waitcnt lgkmcnt(3)
    v_smfmac_f32_32x32x32_bf16 v[48:63], v[100:103], v[40:47], v104
    ds_read_b128 v[100:103], v106 offset:19456
    v_exp_f32 v18, v18
    v_exp_f32 v19, v19
    v_exp_f32 v20, v20
    s_waitcnt lgkmcnt(2)
    v_mfma_f32_32x32x16_bf16 v[32:47], v[88:91], v[80:83], v[64:79]
    v_exp_f32 v21, v21
    v_exp_f32 v22, v22
    v_exp_f32 v23, v23
    v_mfma_f32_32x32x16_bf16 v[32:47], v[92:95], v[84:87], v[32:47]
    ds_read_b128 v[88:91], v105 offset:0
    ds_read_b128 v[92:95], v105 offset:1024
    v_exp_f32 v24, v24
    v_exp_f32 v25, v25
    v_exp_f32 v26, v26
    v_exp_f32 v27, v27
    s_waitcnt lgkmcnt(3)
    v_smfmac_f32_32x32x32_bf16 v[48:63], v[96:99], v[16:23], v104
    ds_read_b128 v[96:99], v106 offset:22528
    v_exp_f32 v28, v28
    v_exp_f32 v29, v29
    v_exp_f32 v30, v30
    v_exp_f32 v31, v31
    s_setprio 0
    v_exp_f32 v32, v32
    v_exp_f32 v33, v33
    s_waitcnt lgkmcnt(3)
    v_smfmac_f32_32x32x32_bf16 v[48:63], v[100:103], v[24:31], v104
    ds_read_b128 v[100:103], v106 offset:23552
    v_exp_f32 v34, v34
    v_exp_f32 v35, v35
    v_exp_f32 v36, v36
    s_waitcnt lgkmcnt(2)
    v_mfma_f32_32x32x16_bf16 v[16:31], v[88:91], v[80:83], v[64:79]
    v_exp_f32 v37, v37
    v_exp_f32 v38, v38
    v_exp_f32 v39, v39
    v_mfma_f32_32x32x16_bf16 v[16:31], v[92:95], v[84:87], v[16:31]
    ds_read_b128 v[88:91], v105 offset:4096
    ds_read_b128 v[92:95], v105 offset:5120
    v_exp_f32 v40, v40
    v_exp_f32 v41, v41
    v_exp_f32 v42, v42
    v_exp_f32 v43, v43
    s_waitcnt lgkmcnt(3)
    v_smfmac_f32_32x32x32_bf16 v[48:63], v[96:99], v[32:39], v104
    ds_read_b128 v[96:99], v105 offset:2048
    v_exp_f32 v44, v44
    v_exp_f32 v45, v45
    v_exp_f32 v46, v46
    v_exp_f32 v47, v47
    s_setprio 0
    v_exp_f32 v16, v16
    v_exp_f32 v17, v17
    s_waitcnt lgkmcnt(3)
    v_smfmac_f32_32x32x32_bf16 v[48:63], v[100:103], v[40:47], v104
    ds_read_b128 v[100:103], v105 offset:3072
    v_exp_f32 v18, v18
    v_exp_f32 v19, v19
    v_exp_f32 v20, v20
    s_waitcnt lgkmcnt(2)
    v_mfma_f32_32x32x16_bf16 v[32:47], v[88:91], v[80:83], v[64:79]
    v_exp_f32 v21, v21
    v_exp_f32 v22, v22
    v_exp_f32 v23, v23
    v_mfma_f32_32x32x16_bf16 v[32:47], v[92:95], v[84:87], v[32:47]
    s_barrier
    s_setprio 2
    ds_read_b128 v[88:91], v105 offset:16384
    ds_read_b128 v[92:95], v105 offset:17408
    v_exp_f32 v24, v24
    v_exp_f32 v25, v25
    v_exp_f32 v26, v26
    v_exp_f32 v27, v27
    s_waitcnt lgkmcnt(3)
    v_smfmac_f32_32x32x32_bf16 v[48:63], v[96:99], v[16:23], v104
    ds_read_b128 v[96:99], v105 offset:6144
    v_exp_f32 v28, v28
    v_exp_f32 v29, v29
    v_exp_f32 v30, v30
    v_exp_f32 v31, v31
    s_setprio 2
    v_exp_f32 v32, v32
    v_exp_f32 v33, v33
    s_waitcnt lgkmcnt(3)
    v_smfmac_f32_32x32x32_bf16 v[48:63], v[100:103], v[24:31], v104
    ds_read_b128 v[100:103], v105 offset:7168
    v_exp_f32 v34, v34
    v_exp_f32 v35, v35
    v_exp_f32 v36, v36
    s_waitcnt lgkmcnt(2)
    v_mfma_f32_32x32x16_bf16 v[16:31], v[88:91], v[80:83], v[64:79]
    v_exp_f32 v37, v37
    v_exp_f32 v38, v38
    v_exp_f32 v39, v39
    v_mfma_f32_32x32x16_bf16 v[16:31], v[92:95], v[84:87], v[16:31]
    ds_read_b128 v[88:91], v105 offset:20480
    ds_read_b128 v[92:95], v105 offset:21504
    v_exp_f32 v40, v40
    v_exp_f32 v41, v41
    v_exp_f32 v42, v42
    v_exp_f32 v43, v43
    s_waitcnt lgkmcnt(3)
    v_smfmac_f32_32x32x32_bf16 v[48:63], v[96:99], v[32:39], v104
    ds_read_b128 v[96:99], v105 offset:18432
    v_exp_f32 v44, v44
    v_exp_f32 v45, v45
    v_exp_f32 v46, v46
    v_exp_f32 v47, v47
    s_setprio 1
    v_exp_f32 v16, v16
    v_exp_f32 v17, v17
    s_waitcnt lgkmcnt(3)
    v_smfmac_f32_32x32x32_bf16 v[48:63], v[100:103], v[40:47], v104
    ds_read_b128 v[100:103], v105 offset:19456
    v_exp_f32 v18, v18
    v_exp_f32 v19, v19
    v_exp_f32 v20, v20
    s_waitcnt lgkmcnt(2)
    v_mfma_f32_32x32x16_bf16 v[32:47], v[88:91], v[80:83], v[64:79]
    v_exp_f32 v21, v21
    v_exp_f32 v22, v22
    v_exp_f32 v23, v23
    v_mfma_f32_32x32x16_bf16 v[32:47], v[92:95], v[84:87], v[32:47]
    ds_read_b128 v[88:91], v105 offset:32768
    ds_read_b128 v[92:95], v105 offset:33792
    v_exp_f32 v24, v24
    v_exp_f32 v25, v25
    v_exp_f32 v26, v26
    v_exp_f32 v27, v27
    s_waitcnt lgkmcnt(3)
    v_smfmac_f32_32x32x32_bf16 v[48:63], v[96:99], v[16:23], v104
    ds_read_b128 v[96:99], v105 offset:22528
    v_exp_f32 v28, v28
    v_exp_f32 v29, v29
    v_exp_f32 v30, v30
    v_exp_f32 v31, v31
    s_setprio 0
    v_exp_f32 v32, v32
    v_exp_f32 v33, v33
    s_waitcnt lgkmcnt(3)
    v_smfmac_f32_32x32x32_bf16 v[48:63], v[100:103], v[24:31], v104
    ds_read_b128 v[100:103], v105 offset:23552
    v_exp_f32 v34, v34
    v_exp_f32 v35, v35
    v_exp_f32 v36, v36
    s_waitcnt lgkmcnt(2)
    v_mfma_f32_32x32x16_bf16 v[16:31], v[88:91], v[80:83], v[64:79]
    v_exp_f32 v37, v37
    v_exp_f32 v38, v38
    v_exp_f32 v39, v39
    v_mfma_f32_32x32x16_bf16 v[16:31], v[92:95], v[84:87], v[16:31]
    ds_read_b128 v[88:91], v105 offset:36864
    ds_read_b128 v[92:95], v105 offset:37888
    v_exp_f32 v40, v40
    v_exp_f32 v41, v41
    v_exp_f32 v42, v42
    v_exp_f32 v43, v43
    s_waitcnt lgkmcnt(3)
    v_smfmac_f32_32x32x32_bf16 v[48:63], v[96:99], v[32:39], v104
    ds_read_b128 v[96:99], v105 offset:34816
    v_exp_f32 v44, v44
    v_exp_f32 v45, v45
    v_exp_f32 v46, v46
    v_exp_f32 v47, v47
    s_setprio 0
    v_exp_f32 v16, v16
    v_exp_f32 v17, v17
    s_waitcnt lgkmcnt(3)
    v_smfmac_f32_32x32x32_bf16 v[48:63], v[100:103], v[40:47], v104
    ds_read_b128 v[100:103], v105 offset:35840
    v_exp_f32 v18, v18
    v_exp_f32 v19, v19
    v_exp_f32 v20, v20
    s_waitcnt lgkmcnt(2)
    v_mfma_f32_32x32x16_bf16 v[32:47], v[88:91], v[80:83], v[64:79]
    v_exp_f32 v21, v21
    v_exp_f32 v22, v22
    v_exp_f32 v23, v23
    v_mfma_f32_32x32x16_bf16 v[32:47], v[92:95], v[84:87], v[32:47]
    s_barrier
    s_setprio 2
    ds_read_b128 v[88:91], v105 offset:49152
    ds_read_b128 v[92:95], v105 offset:50176
    v_exp_f32 v24, v24
    v_exp_f32 v25, v25
    v_exp_f32 v26, v26
    v_exp_f32 v27, v27
    s_waitcnt lgkmcnt(3)
    v_smfmac_f32_32x32x32_bf16 v[48:63], v[96:99], v[16:23], v104
    ds_read_b128 v[96:99], v105 offset:38912
    v_exp_f32 v28, v28
    v_exp_f32 v29, v29
    v_exp_f32 v30, v30
    v_exp_f32 v31, v31
    s_setprio 2
    v_exp_f32 v32, v32
    v_exp_f32 v33, v33
    s_waitcnt lgkmcnt(3)
    v_smfmac_f32_32x32x32_bf16 v[48:63], v[100:103], v[24:31], v104
    ds_read_b128 v[100:103], v105 offset:39936
    v_exp_f32 v34, v34
    v_exp_f32 v35, v35
    v_exp_f32 v36, v36
    s_waitcnt lgkmcnt(2)
    v_mfma_f32_32x32x16_bf16 v[16:31], v[88:91], v[80:83], v[64:79]
    v_exp_f32 v37, v37
    v_exp_f32 v38, v38
    v_exp_f32 v39, v39
    v_mfma_f32_32x32x16_bf16 v[16:31], v[92:95], v[84:87], v[16:31]
    ds_read_b128 v[88:91], v105 offset:53248
    ds_read_b128 v[92:95], v105 offset:54272
    v_exp_f32 v40, v40
    v_exp_f32 v41, v41
    v_exp_f32 v42, v42
    v_exp_f32 v43, v43
    s_waitcnt lgkmcnt(3)
    v_smfmac_f32_32x32x32_bf16 v[48:63], v[96:99], v[32:39], v104
    ds_read_b128 v[96:99], v105 offset:51200
    v_exp_f32 v44, v44
    v_exp_f32 v45, v45
    v_exp_f32 v46, v46
    v_exp_f32 v47, v47
    s_setprio 1
    v_exp_f32 v16, v16
    v_exp_f32 v17, v17
    s_waitcnt lgkmcnt(3)
    v_smfmac_f32_32x32x32_bf16 v[48:63], v[100:103], v[40:47], v104
    ds_read_b128 v[100:103], v105 offset:52224
    v_exp_f32 v18, v18
    v_exp_f32 v19, v19
    v_exp_f32 v20, v20
    s_waitcnt lgkmcnt(2)
    v_mfma_f32_32x32x16_bf16 v[32:47], v[88:91], v[80:83], v[64:79]
    v_exp_f32 v21, v21
    v_exp_f32 v22, v22
    v_exp_f32 v23, v23
    v_mfma_f32_32x32x16_bf16 v[32:47], v[92:95], v[84:87], v[32:47]
    ds_read_b128 v[88:91], v106 offset:0
    ds_read_b128 v[92:95], v106 offset:1024
    v_exp_f32 v24, v24
    v_exp_f32 v25, v25
    v_exp_f32 v26, v26
    v_exp_f32 v27, v27
    s_waitcnt lgkmcnt(3)
    v_smfmac_f32_32x32x32_bf16 v[48:63], v[96:99], v[16:23], v104
    ds_read_b128 v[96:99], v105 offset:55296
    v_exp_f32 v28, v28
    v_exp_f32 v29, v29
    v_exp_f32 v30, v30
    v_exp_f32 v31, v31
    s_setprio 0
    v_exp_f32 v32, v32
    v_exp_f32 v33, v33
    s_waitcnt lgkmcnt(3)
    v_smfmac_f32_32x32x32_bf16 v[48:63], v[100:103], v[24:31], v104
    ds_read_b128 v[100:103], v105 offset:56320
    v_exp_f32 v34, v34
    v_exp_f32 v35, v35
    v_exp_f32 v36, v36
    s_waitcnt lgkmcnt(2)
    v_mfma_f32_32x32x16_bf16 v[16:31], v[88:91], v[80:83], v[64:79]
    v_exp_f32 v37, v37
    v_exp_f32 v38, v38
    v_exp_f32 v39, v39
    v_mfma_f32_32x32x16_bf16 v[16:31], v[92:95], v[84:87], v[16:31]
    ds_read_b128 v[88:91], v106 offset:4096
    ds_read_b128 v[92:95], v106 offset:5120
    v_exp_f32 v40, v40
    v_exp_f32 v41, v41
    v_exp_f32 v42, v42
    v_exp_f32 v43, v43
    s_waitcnt lgkmcnt(3)
    v_smfmac_f32_32x32x32_bf16 v[48:63], v[96:99], v[32:39], v104
    ds_read_b128 v[96:99], v106 offset:2048
    v_exp_f32 v44, v44
    v_exp_f32 v45, v45
    v_exp_f32 v46, v46
    v_exp_f32 v47, v47
    s_setprio 0
    v_exp_f32 v16, v16
    v_exp_f32 v17, v17
    s_waitcnt lgkmcnt(3)
    v_smfmac_f32_32x32x32_bf16 v[48:63], v[100:103], v[40:47], v104
    ds_read_b128 v[100:103], v106 offset:3072
    v_exp_f32 v18, v18
    v_exp_f32 v19, v19
    v_exp_f32 v20, v20
    s_waitcnt lgkmcnt(2)
    v_mfma_f32_32x32x16_bf16 v[32:47], v[88:91], v[80:83], v[64:79]
    v_exp_f32 v21, v21
    v_exp_f32 v22, v22
    v_exp_f32 v23, v23
    v_mfma_f32_32x32x16_bf16 v[32:47], v[92:95], v[84:87], v[32:47]
    s_barrier
    s_setprio 2
    ds_read_b128 v[88:91], v106 offset:16384
    ds_read_b128 v[92:95], v106 offset:17408
    v_exp_f32 v24, v24
    v_exp_f32 v25, v25
    v_exp_f32 v26, v26
    v_exp_f32 v27, v27
    s_waitcnt lgkmcnt(3)
    v_smfmac_f32_32x32x32_bf16 v[48:63], v[96:99], v[16:23], v104
    ds_read_b128 v[96:99], v106 offset:6144
    v_exp_f32 v28, v28
    v_exp_f32 v29, v29
    v_exp_f32 v30, v30
    v_exp_f32 v31, v31
    s_setprio 2
    v_exp_f32 v32, v32
    v_exp_f32 v33, v33
    s_waitcnt lgkmcnt(3)
    v_smfmac_f32_32x32x32_bf16 v[48:63], v[100:103], v[24:31], v104
    ds_read_b128 v[100:103], v106 offset:7168
    v_exp_f32 v34, v34
    v_exp_f32 v35, v35
    v_exp_f32 v36, v36
    s_waitcnt lgkmcnt(2)
    v_mfma_f32_32x32x16_bf16 v[16:31], v[88:91], v[80:83], v[64:79]
    v_exp_f32 v37, v37
    v_exp_f32 v38, v38
    v_exp_f32 v39, v39
    v_mfma_f32_32x32x16_bf16 v[16:31], v[92:95], v[84:87], v[16:31]
    ds_read_b128 v[88:91], v106 offset:20480
    ds_read_b128 v[92:95], v106 offset:21504
    v_exp_f32 v40, v40
    v_exp_f32 v41, v41
    v_exp_f32 v42, v42
    v_exp_f32 v43, v43
    s_waitcnt lgkmcnt(3)
    v_smfmac_f32_32x32x32_bf16 v[48:63], v[96:99], v[32:39], v104
    ds_read_b128 v[96:99], v106 offset:18432
    v_exp_f32 v44, v44
    v_exp_f32 v45, v45
    v_exp_f32 v46, v46
    v_exp_f32 v47, v47
    s_setprio 1
    v_exp_f32 v16, v16
    v_exp_f32 v17, v17
    s_waitcnt lgkmcnt(3)
    v_smfmac_f32_32x32x32_bf16 v[48:63], v[100:103], v[40:47], v104
    ds_read_b128 v[100:103], v106 offset:19456
    v_exp_f32 v18, v18
    v_exp_f32 v19, v19
    v_exp_f32 v20, v20
    s_waitcnt lgkmcnt(2)
    v_mfma_f32_32x32x16_bf16 v[32:47], v[88:91], v[80:83], v[64:79]
    v_exp_f32 v21, v21
    v_exp_f32 v22, v22
    v_exp_f32 v23, v23
    v_mfma_f32_32x32x16_bf16 v[32:47], v[92:95], v[84:87], v[32:47]
    v_exp_f32 v24, v24
    v_exp_f32 v25, v25
    v_exp_f32 v26, v26
    v_exp_f32 v27, v27
    s_waitcnt lgkmcnt(1)
    v_smfmac_f32_32x32x32_bf16 v[48:63], v[96:99], v[16:23], v104
    ds_read_b128 v[96:99], v106 offset:22528
    s_nop 1
    v_exp_f32 v28, v28
    v_exp_f32 v29, v29
    v_exp_f32 v30, v30
    v_exp_f32 v31, v31
    s_setprio 0
    v_exp_f32 v32, v32
    v_exp_f32 v33, v33
    s_waitcnt lgkmcnt(1)
    v_smfmac_f32_32x32x32_bf16 v[48:63], v[100:103], v[24:31], v104
    ds_read_b128 v[100:103], v106 offset:23552
    v_exp_f32 v34, v34
    v_exp_f32 v35, v35
    v_exp_f32 v36, v36
    v_exp_f32 v37, v37
    v_exp_f32 v38, v38
    v_exp_f32 v39, v39
    v_exp_f32 v40, v40
    v_exp_f32 v41, v41
    v_exp_f32 v42, v42
    v_exp_f32 v43, v43
    s_waitcnt lgkmcnt(1)
    v_smfmac_f32_32x32x32_bf16 v[48:63], v[96:99], v[32:39], v104
    v_exp_f32 v44, v44
    v_exp_f32 v45, v45
    v_exp_f32 v46, v46
    v_exp_f32 v47, v47
    s_waitcnt lgkmcnt(0)
    s_nop 0
    v_smfmac_f32_32x32x32_bf16 v[48:63], v[100:103], v[40:47], v104
    s_lshl_b32 s51, s35, 2
    s_add_u32 s51, s51, s50
    s_lshl_b32 s51, s51, 4
    s_add_u32 s51, s51, s34
    s_lshl_b32 s51, s51, 11
    s_add_u32 s51, s51, 13107200
    s_mov_b32 s62, 0x12800000
    s_setprio 2
    s_cmp_ge_u32 s3, 4
    s_nop 1
    s_cbranch_scc1 L_fin1
    ds_write_b128 v107, v[56:59]
    v_cndmask_b32 v32, v60, v48, s[64:65]
    ds_write_b128 v107, v[60:63] offset:1024
    ds_write_b32 v125, v32
    s_waitcnt lgkmcnt(0)
    s_barrier
    ds_read_b32 v33, v126
    ds_read_b128 v[108:111], v124
    ds_read_b128 v[112:115], v124 offset:1024
    s_waitcnt lgkmcnt(2)
    v_add_f32 v32, v32, v33
    v_mov_b32 v33, v32
    s_waitcnt lgkmcnt(0)
    s_nop 0
    v_permlane32_swap_b32 v32, v33
    v_pk_add_f32 v[48:49], v[48:49], v[108:109]
    v_pk_add_f32 v[50:51], v[50:51], v[110:111]
    v_pk_add_f32 v[52:53], v[52:53], v[112:113]
    v_pk_add_f32 v[54:55], v[54:55], v[114:115]
    v_cndmask_b32 v32, v33, v32, s[64:65]
    v_maximum3_f32 v8, |v52|, |v53|, |v54|
    v_rcp_f32 v34, v32
    v_maximum3_f32 v9, |v48|, |v49|, |v50|
    v_maximum3_f32 v8, v8, |v55|, |v55|
    v_maximum3_f32 v9, v9, |v51|, v32
    v_cmp_gt_f32 s[60:61], s62, v8
    v_maximum3_f32 v9, v9, v8, v8
    v_cndmask_b32 v36, v34, 0, s[66:67]
    v_cmp_ngt_f32 vcc, 0x7b800000, v9
    v_pk_mul_f32 v[52:53], v[52:53], v[34:35] op_sel_hi:[1,0]
    s_or_b64 vcc, vcc, s[60:61]
    s_cbranch_scc1 L_fallback
    v_pk_mul_f32 v[54:55], v[54:55], v[34:35] op_sel_hi:[1,0]
    v_pk_mul_f32 v[48:49], v[48:49], v[36:37] op_sel_hi:[1,0]
    v_pk_mul_f32 v[50:51], v[50:51], v[36:37] op_sel_hi:[1,0]
    v_cvt_pk_bf16_f32 v40, v48, v49
    v_cvt_pk_bf16_f32 v41, v50, v51
    v_cvt_pk_bf16_f32 v42, v52, v53
    v_cvt_pk_bf16_f32 v43, v54, v55
    buffer_store_dwordx4 v[40:43], v6, s[20:23], s51 offen offset:0 sc1
    s_barrier
    s_branch L_g0o
L_fin1:
    ds_write_b128 v107, v[48:51]
    v_cndmask_b32 v32, v60, v48, s[64:65]
    ds_write_b128 v107, v[52:55] offset:1024
    ds_write_b32 v125, v32
    s_waitcnt lgkmcnt(0)
    s_barrier
    ds_read_b32 v33, v126
    ds_read_b128 v[108:111], v124
    ds_read_b128 v[112:115], v124 offset:1024
    s_waitcnt lgkmcnt(2)
    v_add_f32 v32, v32, v33
    v_mov_b32 v33, v32
    s_waitcnt lgkmcnt(0)
    s_nop 0
    v_permlane32_swap_b32 v32, v33
    v_pk_add_f32 v[56:57], v[56:57], v[108:109]
    v_pk_add_f32 v[58:59], v[58:59], v[110:111]
    v_pk_add_f32 v[60:61], v[60:61], v[112:113]
    v_pk_add_f32 v[62:63], v[62:63], v[114:115]
    v_cndmask_b32 v32, v33, v32, s[64:65]
    v_maximum3_f32 v8, |v56|, |v57|, |v58|
    v_rcp_f32 v34, v32
    v_maximum3_f32 v9, |v60|, |v61|, |v62|
    v_maximum3_f32 v8, v8, |v59|, |v59|
    v_maximum3_f32 v9, v9, |v63|, v32
    v_cmp_gt_f32 s[60:61], s62, v8
    v_maximum3_f32 v9, v9, v8, v8
    v_cndmask_b32 v36, v34, 0, s[70:71]
    v_cmp_ngt_f32 vcc, 0x7b800000, v9
    v_pk_mul_f32 v[56:57], v[56:57], v[34:35] op_sel_hi:[1,0]
    s_or_b64 vcc, vcc, s[60:61]
    s_cbranch_scc1 L_fallback
    v_pk_mul_f32 v[58:59], v[58:59], v[34:35] op_sel_hi:[1,0]
    v_pk_mul_f32 v[60:61], v[60:61], v[36:37] op_sel_hi:[1,0]
    v_pk_mul_f32 v[62:63], v[62:63], v[36:37] op_sel_hi:[1,0]
    v_cvt_pk_bf16_f32 v40, v56, v57
    v_cvt_pk_bf16_f32 v41, v58, v59
    v_cvt_pk_bf16_f32 v42, v60, v61
    v_cvt_pk_bf16_f32 v43, v62, v63
    buffer_store_dwordx4 v[40:43], v6, s[20:23], s51 offen offset:1024 sc1
    s_barrier
    s_branch L_end
L_g0o:
    s_setprio 0
    s_cmp_eq_u32 s45, 0
    s_cbranch_scc1 L_end
    s_waitcnt vmcnt(0)
    s_and_b32 s55, s50, 1
    s_lshl_b32 s52, s43, 1
    s_add_u32 s55, s55, s52
    s_lshr_b32 s51, s50, 1
    s_lshl_b32 s52, s55, 15
    s_lshl_b32 s53, s51, 14
    s_add_u32 s52, s52, s53
    s_add_u32 s52, s52, 13107200
    s_mul_i32 s55, s55, 57344
    s_lshl_b32 s53, s44, 7
    s_add_u32 s55, s55, s53
    s_lshl_b32 s53, s51, 6
    s_add_u32 s55, s55, s53
    s_add_u32 s55, s55, 896
    s_lshl_b32 s53, s50, 12
    s_xor_b32 s54, s53, 0x2000
    s_add_u32 s53, s53, 114688
    s_add_u32 s54, s54, 114688
    s_mul_i32 s57, s51, 28672
    s_add_u32 s57, s57, 0
    s_lshl_b32 s58, s50, 2
    s_add_u32 s58, s58, 131088
    v_lshrrev_b32 v7, 5, v0
    v_bfe_u32 v4, v0, 2, 2
    v_lshl_add_u32 v144, v7, 3, v4
    v_lshlrev_b32 v144, 7, v144
    v_lshrrev_b32 v4, 1, v4
    v_xor_b32 v4, 0, v4
    v_lshl_add_u32 v144, v4, 6, v144
    v_bfe_u32 v4, v0, 4, 1
    v_lshl_add_u32 v144, v4, 5, v144
    v_and_b32 v4, 1, v0
    v_lshl_add_u32 v144, v4, 4, v144
    v_bfe_u32 v4, v0, 1, 1
    v_lshl_add_u32 v144, v4, 3, v144
    v_add_u32 v144, s57, v144
    v_xor_b32 v145, 64, v144
    v_add_u32 v146, s53, v6
    v_add_u32 v147, s54, v6
    v_mov_b32 v148, s58
    v_xor_b32 v149, 8, v148
    v_mov_b32 v150, 1
    v_mul_u32_u24 v151, 1792, v1
    v_lshl_add_u32 v151, v2, 4, v151
    v_add_u32 v152, 0x1000, v6
    v_add_u32 v153, 0x2000, v6
    v_add_u32 v154, 0x3000, v6
    buffer_load_dwordx4 v[16:19], v6, s[20:23], s52 offen offset:0 sc1
    buffer_load_dwordx4 v[20:23], v6, s[20:23], s52 offen offset:1024 sc1
    buffer_load_dwordx4 v[24:27], v6, s[20:23], s52 offen offset:2048 sc1
    buffer_load_dwordx4 v[28:31], v6, s[20:23], s52 offen offset:3072 sc1
    buffer_load_dwordx4 v[32:35], v152, s[20:23], s52 offen offset:0 sc1
    buffer_load_dwordx4 v[36:39], v152, s[20:23], s52 offen offset:1024 sc1
    buffer_load_dwordx4 v[40:43], v152, s[20:23], s52 offen offset:2048 sc1
    buffer_load_dwordx4 v[44:47], v152, s[20:23], s52 offen offset:3072 sc1
    buffer_load_dwordx4 v[48:51], v153, s[20:23], s52 offen offset:0 sc1
    buffer_load_dwordx4 v[52:55], v153, s[20:23], s52 offen offset:1024 sc1
    buffer_load_dwordx4 v[56:59], v153, s[20:23], s52 offen offset:2048 sc1
    buffer_load_dwordx4 v[60:63], v153, s[20:23], s52 offen offset:3072 sc1
    buffer_load_dwordx4 v[64:67], v154, s[20:23], s52 offen offset:0 sc1
    buffer_load_dwordx4 v[68:71], v154, s[20:23], s52 offen offset:1024 sc1
    buffer_load_dwordx4 v[72:75], v154, s[20:23], s52 offen offset:2048 sc1
    buffer_load_dwordx4 v[76:79], v154, s[20:23], s52 offen offset:3072 sc1
    s_branch L_oproj
L_fallback:
    s_barrier
    v_and_b32 v7, 31, v3
    s_lshl_b32 s54, s36, 2
    v_subrev_u32 v8, s54, v7
    v_cmp_gt_u32 s[60:61], 28, v8
    v_mul_u32_u24 v9, 448, v2
    v_lshl_add_u32 v8, v8, 4, v9
    v_add_u32 v8, 256, v8
    v_mov_b32 v7, 0xff800000
    s_add_u32 s54, s37, 1835008
    s_mov_b32 s56, 64
L_fb1:
    buffer_load_dwordx4 v[88:91], v5, s[20:23], s54 offen sc1
    buffer_load_dwordx4 v[92:95], v5, s[20:23], s54 offen offset:1024 sc1
    s_add_u32 s54, s54, 28672
    s_waitcnt vmcnt(0)
    v_mfma_f32_32x32x16_bf16 v[16:31], v[88:91], v[80:83], 0
    v_mfma_f32_32x32x16_bf16 v[16:31], v[92:95], v[84:87], v[16:31]
    s_nop 11
    v_max3_f32 v7, v7, v16, v17
    v_max3_f32 v7, v7, v18, v19
    v_max3_f32 v7, v7, v20, v21
    v_max3_f32 v7, v7, v22, v23
    v_max3_f32 v7, v7, v24, v25
    v_max3_f32 v7, v7, v26, v27
    v_max3_f32 v7, v7, v28, v29
    v_max3_f32 v7, v7, v30, v31
    s_sub_u32 s56, s56, 1
    s_cmp_lg_u32 s56, 0
    s_cbranch_scc1 L_fb1
    v_mov_b32 v9, v7
    s_nop 1
    v_permlane32_swap_b32 v7, v9
    v_max_f32 v7, v7, v9
    v_sub_f32 v64, 0, v7
    v_mov_b32 v48, 0
    v_sub_f32 v65, 0, v7
    v_mov_b32 v49, 0
    v_sub_f32 v66, 0, v7
    v_mov_b32 v50, 0
    v_sub_f32 v67, 0, v7
    v_mov_b32 v51, 0
    v_sub_f32 v68, 0, v7
    v_mov_b32 v52, 0
    v_sub_f32 v69, 0, v7
    v_mov_b32 v53, 0
    v_sub_f32 v70, 0, v7
    v_mov_b32 v54, 0
    v_sub_f32 v71, 0, v7
    v_mov_b32 v55, 0
    v_sub_f32 v72, 0, v7
    v_mov_b32 v56, 0
    v_sub_f32 v73, 0, v7
    v_mov_b32 v57, 0
    v_sub_f32 v74, 0, v7
    v_mov_b32 v58, 0
    v_sub_f32 v75, 0, v7
    v_mov_b32 v59, 0
    v_sub_f32 v76, 0, v7
    v_mov_b32 v60, 0
    v_sub_f32 v77, 0, v7
    v_mov_b32 v61, 0
    v_sub_f32 v78, 0, v7
    v_mov_b32 v62, 0
    v_sub_f32 v79, 0, v7
    v_mov_b32 v63, 0
    v_mov_b32 v96, 0x4f804f80
    v_mov_b32 v97, 0x4f804f80
    v_mov_b32 v98, 0x4f804f80
    v_mov_b32 v99, 0x4f804f80
    v_mov_b32 v100, 0x4f804f80
    v_mov_b32 v101, 0x4f804f80
    v_mov_b32 v102, 0x4f804f80
    v_mov_b32 v103, 0x4f804f80
    s_add_u32 s54, s37, 1835008
    s_mul_i32 s57, s34, 114688
    s_add_u32 s57, s57, 3669760
    s_mov_b32 s56, 64
L_fb2:
    buffer_load_dwordx4 v[88:91], v5, s[20:23], s54 offen sc1
    buffer_load_dwordx4 v[92:95], v5, s[20:23], s54 offen offset:1024 sc1
    s_mov_b64 exec, s[60:61]
    buffer_load_dwordx4 v[96:99], v8, s[20:23], s57 offen sc1
    buffer_load_dwordx4 v[100:103], v8, s[20:23], s57 offen offset:896 sc1
    s_mov_b64 exec, -1
    s_add_u32 s54, s54, 28672
    s_add_u32 s57, s57, 1792
    s_waitcnt vmcnt(0)
    v_mfma_f32_32x32x16_bf16 v[16:31], v[88:91], v[80:83], v[64:79]
    v_mfma_f32_32x32x16_bf16 v[16:31], v[92:95], v[84:87], v[16:31]
    s_nop 11
    v_exp_f32 v16, v16
    v_exp_f32 v17, v17
    v_exp_f32 v18, v18
    v_exp_f32 v19, v19
    v_exp_f32 v20, v20
    v_exp_f32 v21, v21
    v_exp_f32 v22, v22
    v_exp_f32 v23, v23
    v_exp_f32 v24, v24
    v_exp_f32 v25, v25
    v_exp_f32 v26, v26
    v_exp_f32 v27, v27
    v_exp_f32 v28, v28
    v_exp_f32 v29, v29
    v_exp_f32 v30, v30
    v_exp_f32 v31, v31
    s_nop 1
    v_smfmac_f32_32x32x32_bf16 v[48:63], v[96:99], v[16:23], v104
    v_smfmac_f32_32x32x32_bf16 v[48:63], v[100:103], v[24:31], v104
    s_sub_u32 s56, s56, 1
    s_cmp_lg_u32 s56, 0
    s_nop 7
    s_cbranch_scc1 L_fb2
    s_nop 7
    s_cmp_ge_u32 s3, 4
    s_cbranch_scc1 L_fbh1
    v_cndmask_b32 v32, v60, v48, s[64:65]
    v_cndmask_b32 v33, v60, v48, s[64:65]
    s_nop 1
    v_permlane32_swap_b32 v32, v33
    v_cndmask_b32 v32, v33, v32, s[64:65]
    v_rcp_f32 v34, v32
    s_nop 0
    v_cndmask_b32 v36, v34, 0, s[66:67]
    v_cndmask_b32 v38, v34, 0, s[70:71]
    v_pk_mul_f32 v[48:49], v[48:49], v[36:37] op_sel_hi:[1,0]
    v_pk_mul_f32 v[50:51], v[50:51], v[36:37] op_sel_hi:[1,0]
    v_pk_mul_f32 v[52:53], v[52:53], v[34:35] op_sel_hi:[1,0]
    v_pk_mul_f32 v[54:55], v[54:55], v[34:35] op_sel_hi:[1,0]
    v_cvt_pk_bf16_f32 v40, v48, v49
    v_min_u32 v40, -2, v40
    v_cvt_pk_bf16_f32 v41, v50, v51
    v_min_u32 v41, -2, v41
    v_cvt_pk_bf16_f32 v42, v52, v53
    v_min_u32 v42, -2, v42
    v_cvt_pk_bf16_f32 v43, v54, v55
    v_min_u32 v43, -2, v43
    buffer_store_dwordx4 v[40:43], v6, s[20:23], s51 offen offset:0 sc1
    s_branch L_g0o
L_fbh1:
    v_cndmask_b32 v32, v60, v48, s[64:65]
    v_cndmask_b32 v33, v60, v48, s[64:65]
    s_nop 1
    v_permlane32_swap_b32 v32, v33
    v_cndmask_b32 v32, v33, v32, s[64:65]
    v_rcp_f32 v34, v32
    s_nop 0
    v_cndmask_b32 v36, v34, 0, s[66:67]
    v_cndmask_b32 v38, v34, 0, s[70:71]
    v_pk_mul_f32 v[56:57], v[56:57], v[34:35] op_sel_hi:[1,0]
    v_pk_mul_f32 v[58:59], v[58:59], v[34:35] op_sel_hi:[1,0]
    v_pk_mul_f32 v[60:61], v[60:61], v[38:39] op_sel_hi:[1,0]
    v_pk_mul_f32 v[62:63], v[62:63], v[38:39] op_sel_hi:[1,0]
    v_cvt_pk_bf16_f32 v44, v56, v57
    v_min_u32 v44, -2, v44
    v_cvt_pk_bf16_f32 v45, v58, v59
    v_min_u32 v45, -2, v45
    v_cvt_pk_bf16_f32 v46, v60, v61
    v_min_u32 v46, -2, v46
    v_cvt_pk_bf16_f32 v47, v62, v63
    v_min_u32 v47, -2, v47
    buffer_store_dwordx4 v[44:47], v6, s[20:23], s51 offen offset:1024 sc1
    s_branch L_end
L_end:
L_exit:
    s_endpgm
L_codeend:
.section .rodata,"a"
.p2align 6
.amdhsa_kernel concat_heads__sliding_local_dilated__mha_block__prompt_kernel
  .amdhsa_next_free_vgpr 168
  .amdhsa_next_free_sgpr 102
  .amdhsa_accum_offset 168
  .amdhsa_group_segment_fixed_size 0
  .amdhsa_kernarg_size 72
  .amdhsa_user_sgpr_count 2
  .amdhsa_user_sgpr_kernarg_segment_ptr 1
  .amdhsa_system_sgpr_workgroup_id_x 1
.end_amdhsa_kernel
```
